```python
import torch

def _softmax(x, axis=-1):
    return torch.softmax(x, dim=axis)
def _gelu(x):
    return torch.nn.functional.gelu(x, approximate="tanh")
def _silu(x):
    return torch.nn.functional.silu(x)
def _sigmoid(x):
    return torch.sigmoid(x)
def _layernorm(x, axis=-1, eps=1e-5):
    m = x.mean(dim=axis, keepdim=True)
    v = x.var(dim=axis, keepdim=True, unbiased=False)
    return (x - m) / torch.sqrt(v + eps)
def _scatter_add(tgt, idx, src, axis=0):
    return tgt.clone().index_add_(axis, idx, src)
def _segment_sum(src, seg, n):
    out = torch.zeros((n,) + src.shape[1:], dtype=src.dtype)
    return out.index_add_(0, seg, src)
def _pad(x, pw):
    flat = tuple(v for pair in reversed(pw) for v in pair)
    return torch.nn.functional.pad(x, flat)

kernel_name = 'parallel_sum__mha_block__glu_gated_glu__prompt'

def setup_inputs():

    _w = (lambda a: (lambda t: t.to(torch.bfloat16) if t.is_floating_point() else t)(torch.as_tensor(a)))
    def _A_setup():
        B, S, D, H = 1, 2048, 640, 32
        return {
            "x": _w((lambda *s: torch.randn(*s, dtype=torch.bfloat16) * 0.05)(B, S, D)),
            "wqkv": _w((lambda *s: torch.randn(*s, dtype=torch.bfloat16) * 0.05)(D, 3 * D)),
            "wo": _w((lambda *s: torch.randn(*s, dtype=torch.bfloat16) * 0.05)(D, D)),
        }
    _A_in = _A_setup()

    def _B_setup():
        B, S, D, F = 1, 2048, 640, 1536
        return {
            "x": _w((lambda *s: torch.randn(*s, dtype=torch.bfloat16) * 0.05)(B, S, D)),
            "w_gate": _w((lambda *s: torch.randn(*s, dtype=torch.bfloat16) * 0.05)(D, F)),
            "w_up": _w((lambda *s: torch.randn(*s, dtype=torch.bfloat16) * 0.05)(D, F)),
            "w_down": _w((lambda *s: torch.randn(*s, dtype=torch.bfloat16) * 0.05)(F, D)),
        }
    _B_in = _B_setup()

    return {
        "A_x": _A_in["x"],
        "A_wqkv": _A_in["wqkv"],
        "A_wo": _A_in["wo"],
        "B_x": _B_in["x"],
        "B_w_gate": _B_in["w_gate"],
        "B_w_up": _B_in["w_up"],
        "B_w_down": _B_in["w_down"],
    }

def reference(A_x, A_wqkv, A_wo, B_x, B_w_gate, B_w_up, B_w_down):
    def _A_ref(x, wqkv, wo):
        B, S, D = x.shape
        H = 32
        Dh = D // H
        qkv = (lambda x, *d: x.permute(*d))((x @ wqkv).reshape(B, S, 3, H, Dh), 2, 0, 3, 1, 4)
        q, k, v = qkv[0], qkv[1], qkv[2]
        scores = torch.einsum("bhqd,bhkd->bhqk", q, k) * (Dh ** -0.5)
        p = _softmax(scores, axis=-1)
        o = torch.einsum("bhqk,bhkd->bhqd", p, v)
        return (lambda x, *d: x.permute(*d))(o, 0, 2, 1, 3).reshape(B, S, D) @ wo

    def _B_ref(x, w_gate, w_up, w_down):
        g = torch.einsum("bsd,df->bsf", x, w_gate)
        u = torch.einsum("bsd,df->bsf", x, w_up)
        h = _sigmoid(g) * u
        return torch.einsum("bsf,fd->bsd", h, w_down)

    x = A_x
    xn = _layernorm(x, axis=-1)
    return x + _A_ref(xn, A_wqkv, A_wo) + _B_ref(xn, B_w_gate, B_w_up, B_w_down)
```

```asm
; @launch grid=(256,1,1) block=(512,1,1) lds=163840
.amdgcn_target "amdgcn-amd-amdhsa--gfx950"
.text
.globl parallel_sum__mha_block__glu_gated_glu__prompt_kernel
.p2align 12
.type parallel_sum__mha_block__glu_gated_glu__prompt_kernel,@function
parallel_sum__mha_block__glu_gated_glu__prompt_kernel:
    s_cmp_ge_u32 s2, 256
    s_cbranch_scc1 F_done
    s_setprio 3
    s_load_dwordx8 s[56:63], s[0:1], 0
    s_load_dwordx8 s[64:71], s[0:1], 32
    s_load_dwordx4 s[72:75], s[0:1], 64
    s_memrealtime s[32:33]
    s_and_b32 s46, s2, 7
    s_lshr_b32 s47, s2, 3
    s_and_b32 s39, s46, 1
    s_lshl_b32 s39, s39, 3
    s_and_b32 s48, s47, 7
    s_add_u32 s39, s39, s48
    s_lshr_b32 s40, s46, 1
    s_lshl_b32 s40, s40, 2
    s_lshr_b32 s48, s47, 3
    s_add_u32 s40, s40, s48
    s_lshl_b32 s41, s40, 2
    s_mul_i32 s48, s40, 3
    s_add_u32 s48, s48, 12
    s_and_b32 s48, s48, -2
    s_cmp_lt_u32 s40, 12
    s_cselect_b32 s41, s41, s48
    v_lshrrev_b32 v12, 6, v0
    v_and_b32 v0, 63, v0
    v_readfirstlane_b32 s36, v12
    v_lshlrev_b32 v1, 4, v0
    s_lshl_b32 s45, s36, 11
    v_lshrrev_b32 v12, 3, v0
    s_lshl_b32 s46, s39, 7
    s_lshl_b32 s47, s36, 4
    s_add_u32 s46, s46, s47
    v_add_u32 v12, s46, v12
    v_mul_u32_u24 v12, 1280, v12
    v_lshrrev_b32 v13, 4, v0
    v_and_b32 v14, 7, v0
    v_xor_b32 v14, v14, v13
    v_lshl_add_u32 v64, v14, 4, v12
    v_xor_b32 v14, 4, v14
    v_lshl_add_u32 v65, v14, 4, v12
    v_add_u32 v65, 10240, v65
    s_lshl_b32 s46, s36, 3
    v_add_u32 v12, s46, v13
    v_mul_u32_u24 v12, 3840, v12
    v_bfe_u32 v14, v0, 2, 2
    v_xor_b32 v14, v14, v13
    v_lshl_add_u32 v12, v14, 6, v12
    v_and_b32 v14, 3, v0
    v_lshl_add_u32 v12, v14, 4, v12
    s_lshl_b32 s46, s41, 6
    v_add_u32 v66, s46, v12
    v_add_u32 v67, 15360, v66
    s_and_b32 s4, s2, 7
    s_lshl_b32 s4, s4, 2
    s_lshr_b32 s4, 0x16946149, s4
    s_and_b32 s3, s4, 15
    s_lshl_b32 s42, s3, 7
    s_waitcnt lgkmcnt(0)
    s_and_b32 s4, s36, 1
    s_lshl_b32 s4, s4, 21
    s_load_dword s50, s[58:59], s4
    s_mov_b32 s8, s56
    s_and_b32 s9, s57, 0xffff
    s_mov_b32 s10, 2621440
    s_mov_b32 s11, 0x00020000
    s_mov_b32 s12, s58
    s_and_b32 s13, s59, 0xffff
    s_mov_b32 s14, 2457600
    s_mov_b32 s15, 0x00020000
    s_add_u32 m0, s45, 0
    s_add_u32 s42, s42, 128
    s_cmp_eq_u32 s42, 1280
    s_cselect_b32 s42, 0, s42
    buffer_load_dwordx4 v64, s[8:11], s42 offen  lds
    s_add_u32 m0, s45, 1024
    s_nop 0
    buffer_load_dwordx4 v65, s[8:11], s42 offen  lds
    s_add_u32 m0, s45, 65536
    s_mul_i32 s43, s42, 1920
    buffer_load_dwordx4 v66, s[12:15], s43 offen  lds
    s_add_u32 m0, s45, 66560
    s_nop 0
    buffer_load_dwordx4 v67, s[12:15], s43 offen  lds
    s_setprio 0
    s_cmp_lg_u32 s36, 0
    s_cbranch_scc1 F_w01
    s_getpc_b64 s[4:5]
F_pcq:
    s_lshr_b32 s6, s2, 3
    s_lshl_b32 s6, s6, 4
    v_add_u32 v12, s6, v0
    v_lshlrev_b32 v12, 7, v12
    v_min_u32 v12, F_done-F_pcq, v12
    s_mov_b64 exec, 0xffff
    global_load_dword v254, v12, s[4:5]
    s_mov_b64 exec, -1
    s_cmp_lg_u32 s2, 0
    s_cbranch_scc1 F_nonce2
    s_or_b32 s4, s32, 1
    v_mov_b32 v12, s4
    v_mov_b32 v13, s33
    v_mov_b32 v14, 0
    s_mov_b64 exec, 1
    global_store_dwordx2 v14, v[12:13], s[72:73] sc0 sc1
    s_mov_b64 exec, -1
F_nonce2:
F_w01:
    s_cmp_lg_u32 s36, 0
    s_cbranch_scc1 F_tl3
    s_mov_b32 s4, 0
    s_load_dword s50, s[64:65], s4
    s_mov_b32 s4, 0
    s_load_dword s50, s[66:67], s4
    s_mov_b32 s4, 0
    s_load_dword s50, s[68:69], s4
    s_mov_b32 s4, 0
    s_load_dword s50, s[60:61], s4
F_tl3:
    s_cmp_lg_u32 s36, 1
    s_cbranch_scc1 F_tl4
    s_mov_b32 s4, 18874368
    s_load_dword s50, s[74:75], s4
F_tl4:
    s_add_u32 m0, s45, 16384
    s_add_u32 s42, s42, 128
    s_cmp_eq_u32 s42, 1280
    s_cselect_b32 s42, 0, s42
    buffer_load_dwordx4 v64, s[8:11], s42 offen  lds
    s_add_u32 m0, s45, 17408
    s_nop 0
    buffer_load_dwordx4 v65, s[8:11], s42 offen  lds
    s_and_b32 s37, s36, 3
    s_lshr_b32 s38, s36, 2
    s_lshl_b32 s55, s36, 10
    v_and_b32 v12, 31, v0
    v_lshrrev_b32 v13, 5, v0
    v_bfe_u32 v14, v0, 1, 3
    v_xor_b32 v14, v14, v13
    s_lshl_b32 s46, s37, 5
    v_add_u32 v12, s46, v12
    v_lshlrev_b32 v68, 7, v12
    v_lshl_add_u32 v68, v14, 4, v68
    v_xor_b32 v69, 32, v68
    v_xor_b32 v70, 64, v68
    v_xor_b32 v71, 96, v68
    v_bfe_u32 v12, v0, 2, 2
    v_lshl_add_u32 v14, v13, 3, v12
    v_bfe_u32 v15, v0, 4, 1
    v_lshlrev_b32 v72, 8, v14
    s_lshl_b32 s46, s38, 1
    v_xor_b32 v12, s46, v12
    v_lshl_add_u32 v72, v12, 6, v72
    v_lshl_add_u32 v72, v15, 5, v72
    v_and_b32 v12, 3, v0
    v_lshl_add_u32 v72, v12, 3, v72
    v_add_u32 v72, 0x10000, v72
    v_xor_b32 v73, 64, v72
    s_lshr_b32 s46, s2, 3
    s_bfe_u32 s6, s2, 0x20001
    s_lshl_b32 s5, s6, 5
    s_add_u32 s5, s5, s46
    s_and_b32 s4, s2, 1
    s_lshl_b32 s4, s4, 10
    s_lshl_b32 s5, s5, 3
    s_add_u32 s4, s4, s5
    s_add_u32 s54, s4, s36
    v_mul_u32_u24 v79, 20, v0
    s_mov_b32 s24, s74
    s_and_b32 s25, s75, 0xffff
    s_mov_b32 s26, 19711616
    s_mov_b32 s27, 0x00020000
    s_lshl_b32 s52, s36, 8
    s_add_u32 s52, s52, s2
    s_mul_i32 s0, s52, 30841
    s_lshr_b32 s0, s0, 22
    s_mul_i32 s4, s0, 136
    s_sub_u32 s51, s52, s4
    s_add_u32 s74, s52, s4
    s_lshl_b32 s74, s74, 10
    s_add_u32 s74, s74, 16777216
    s_lshl_b32 s0, s0, 7
    s_cmp_lt_u32 s52, 1360
    s_cselect_b32 s0, s0, 1073741824
    s_cselect_b32 s74, s74, 1073741824
    s_cmp_lt_u32 s51, 96
    s_cselect_b32 s76, s68, s60
    s_cselect_b32 s77, s69, s61
    s_mov_b32 s78, 819200
    s_cselect_b32 s78, 1966080, s78
    s_and_b32 s77, s77, 0xffff
    s_mov_b32 s79, 0x00020000
    s_sub_u32 s52, s51, 96
    s_mul_i32 s52, s52, 20
    s_lshl_b32 s4, s51, 4
    s_cmp_lt_u32 s51, 96
    s_cselect_b32 s52, s4, s52
    s_mul_i32 s5, s51, 80
    s_sub_u32 s5, s5, 10224
    s_cmp_lt_u32 s51, 128
    s_cselect_b32 s52, s52, s5
    s_mul_i32 s52, s52, 1280
    s_add_u32 s0, s0, s52
    s_cmp_lt_u32 s51, 128
    s_mov_b32 s1, 51200
    s_cselect_b32 s1, 5120, s1
    s_mov_b32 s5, 25600
    s_cselect_b32 s5, 10240, s5
    v_lshrrev_b32 v255, 5, v0
    v_mul_u32_u24 v255, s5, v255
    v_bfe_u32 v12, v0, 3, 2
    v_mul_u32_u24 v12, 1280, v12
    v_add_u32 v255, v255, v12
    v_and_b32 v12, 0x70, v1
    v_add_u32 v255, v255, v12
    s_cmp_ge_u32 s40, 10
    s_cbranch_scc1 F_v
    s_add_u32 m0, s45, 81920
    s_mul_i32 s43, s42, 1920
    buffer_load_dwordx4 v66, s[12:15], s43 offen  lds
    s_add_u32 m0, s45, 82944
    s_nop 0
    buffer_load_dwordx4 v67, s[12:15], s43 offen  lds
    s_waitcnt lgkmcnt(0)
    s_waitcnt vmcnt(4)
    s_barrier
    ds_read_b128 v[96:99], v68 offset:0
    ds_read_b64_tr_b16 v[16:17], v72 offset:0
    ds_read_b64_tr_b16 v[18:19], v72 offset:1024
    ds_read_b64_tr_b16 v[20:21], v73 offset:0
    ds_read_b64_tr_b16 v[22:23], v73 offset:1024
    s_setprio 1
    s_waitcnt lgkmcnt(2)
    v_mfma_f32_32x32x16_bf16 v[32:47], v[16:19], v[96:99], 0
    ds_read_b128 v[100:103], v69 offset:0
    ds_read_b64_tr_b16 v[24:25], v72 offset:4096
    ds_read_b64_tr_b16 v[26:27], v72 offset:5120
    ds_read_b64_tr_b16 v[28:29], v73 offset:4096
    ds_read_b64_tr_b16 v[30:31], v73 offset:5120
    s_waitcnt lgkmcnt(5)
    v_mfma_f32_32x32x16_bf16 v[48:63], v[20:23], v[96:99], 0
    s_setprio 0
    s_and_b32 s48, s2, 1
    s_lshl_b32 s48, s48, 5
    s_add_u32 s48, s48, s46
    s_mul_i32 s47, s48, 205
    s_lshr_b32 s47, s47, 10
    s_mul_i32 s35, s47, 5
    s_sub_u32 s35, s48, s35
    s_lshl_b32 s4, s35, 3
    s_add_u32 s4, s4, s36
    s_lshl_b32 s4, s4, 4
    v_lshrrev_b32 v93, 3, v0
    v_add_u32 v93, s4, v93
    v_and_b32 v94, 0x70, v1
    v_mul_u32_u24 v92, 3840, v93
    v_add_u32 v92, v92, v94
    v_mul_u32_u24 v95, 3072, v93
    v_add_u32 v95, v95, v94
    s_bfe_u32 s4, s2, 0x20001
    s_lshl_b32 s4, s4, 3
    s_add_u32 s4, s4, s47
    s_lshl_b32 s53, s4, 6
    s_add_u32 m0, s45, 32768
    s_add_u32 s42, s42, 128
    s_cmp_eq_u32 s42, 1280
    s_cselect_b32 s42, 0, s42
    buffer_load_dwordx4 v64, s[8:11], s42 offen  lds
    s_add_u32 m0, s45, 33792
    s_nop 0
    buffer_load_dwordx4 v65, s[8:11], s42 offen  lds
    s_setprio 1
    s_waitcnt lgkmcnt(2)
    v_mfma_f32_32x32x16_bf16 v[32:47], v[24:27], v[100:103], v[32:47]
    ds_read_b128 v[104:107], v70 offset:0
    ds_read_b64_tr_b16 v[16:17], v72 offset:8192
    ds_read_b64_tr_b16 v[18:19], v72 offset:9216
    ds_read_b64_tr_b16 v[20:21], v73 offset:8192
    ds_read_b64_tr_b16 v[22:23], v73 offset:9216
    s_waitcnt lgkmcnt(5)
    v_mfma_f32_32x32x16_bf16 v[48:63], v[28:31], v[100:103], v[48:63]
    s_setprio 0
    s_cmp_lt_u32 s48, 40
    s_cselect_b32 s4, s53, 4096
    s_cmp_lt_u32 s4, 1920
    s_cselect_b32 s53, s53, 268435456
    s_lshl_b32 s34, s53, 1
    s_mul_i32 s35, s35, 19968
    s_and_b32 s4, s36, 1
    s_lshl_b32 s4, s4, 7
    s_add_u32 s35, s35, s4
    s_add_u32 s35, s35, 19578880
    s_lshl_b32 s53, s53, 2
    s_add_u32 s53, s53, s35
    s_cmp_ge_u32 s47, 6
    s_cselect_b32 s28, s66, s64
    s_cselect_b32 s29, s67, s65
    s_cselect_b32 s4, 6144, 0
    s_add_u32 s35, s35, s4
    s_cmp_ge_u32 s47, 6
    s_cselect_b32 s4, 6, 0
    s_sub_u32 s47, s47, s4
    s_and_b32 s29, s29, 0xffff
    s_mov_b32 s30, 1966080
    s_mov_b32 s31, 0x00020000
    s_lshr_b32 s4, s40, 2
    s_mul_i32 s4, s4, 6
    s_add_u32 s4, s4, s47
    s_lshl_b32 s47, s4, 7
    s_add_u32 m0, s45, 98304
    s_mul_i32 s43, s42, 1920
    buffer_load_dwordx4 v66, s[12:15], s43 offen  lds
    s_add_u32 m0, s45, 99328
    s_nop 0
    buffer_load_dwordx4 v67, s[12:15], s43 offen  lds
    ds_read_b128 v[108:111], v71 offset:0
    ds_read_b64_tr_b16 v[24:25], v72 offset:12288
    ds_read_b64_tr_b16 v[26:27], v72 offset:13312
    ds_read_b64_tr_b16 v[28:29], v73 offset:12288
    ds_read_b64_tr_b16 v[30:31], v73 offset:13312
    s_setprio 1
    s_waitcnt lgkmcnt(7)
    v_mfma_f32_32x32x16_bf16 v[32:47], v[16:19], v[104:107], v[32:47]
    s_cmp_lt_u32 s48, 60
    s_cselect_b32 s49, s47, 536870912
    s_mul_i32 s50, s54, 1280
    buffer_load_dwordx4 v[74:77], v79, s[8:11], s50 offen
    buffer_load_dword v78, v79, s[8:11], s50 offen offset:16
    s_add_u32 m0, s45, 49152
    s_add_u32 s42, s42, 128
    s_cmp_eq_u32 s42, 1280
    s_cselect_b32 s42, 0, s42
    buffer_load_dwordx4 v64, s[8:11], s42 offen  lds
    s_waitcnt lgkmcnt(5)
    v_mfma_f32_32x32x16_bf16 v[48:63], v[20:23], v[104:107], v[48:63]
    s_cmp_ge_u32 s36, 4
    s_cbranch_scc1 F_cq0r
    s_cmp_eq_u32 s36, 1
    s_cbranch_scc1 F_cq0w1
    s_cmp_eq_u32 s36, 2
    s_cbranch_scc1 F_cq0w2
    s_cmp_eq_u32 s36, 3
    s_cbranch_scc1 F_cq0w3
    s_call_b64 s[6:7], F_pg1
    s_branch F_cq0r
F_cq0w1:
    s_call_b64 s[6:7], F_pg2
    s_branch F_cq0r
F_cq0w2:
    s_call_b64 s[6:7], F_pj
    s_branch F_cq0r
F_cq0w3:
    s_call_b64 s[6:7], F_pg5
F_cq0r:
    s_waitcnt lgkmcnt(0)
    s_waitcnt vmcnt(7)
    s_barrier
    v_mfma_f32_32x32x16_bf16 v[32:47], v[24:27], v[108:111], v[32:47]
    ds_read_b128 v[112:115], v68 offset:16384
    ds_read_b64_tr_b16 v[16:17], v72 offset:16384
    ds_read_b64_tr_b16 v[18:19], v72 offset:17408
    ds_read_b64_tr_b16 v[20:21], v73 offset:16384
    ds_read_b64_tr_b16 v[22:23], v73 offset:17408
    v_mfma_f32_32x32x16_bf16 v[48:63], v[28:31], v[108:111], v[48:63]
    s_setprio 0
    s_lshl_b32 s54, s54, 3
    s_add_u32 s54, s54, 19562496
    s_cmp_lt_u32 s48, 60
    s_cselect_b32 s4, s47, 536870912
    s_lshl_b32 s4, s4, 1
    s_add_u32 s4, s4, 7680
    s_add_u32 s35, s35, s4
    s_cmp_lt_u32 s36, 6
    s_cselect_b32 s53, s53, s35
    v_lshrrev_b32 v93, 5, v0
    v_bfe_u32 v94, v0, 2, 2
    v_lshl_add_u32 v93, v93, 3, v94
    s_add_u32 m0, s45, 50176
    s_nop 0
    buffer_load_dwordx4 v65, s[8:11], s42 offen  lds
    s_add_u32 m0, s45, 147456
    s_nop 0
    buffer_load_dwordx4 v95, s[28:31], s49 offen lds
    s_setprio 1
    s_waitcnt lgkmcnt(2)
    v_mfma_f32_32x32x16_bf16 v[32:47], v[16:19], v[112:115], v[32:47]
    ds_read_b128 v[116:119], v69 offset:16384
    ds_read_b64_tr_b16 v[24:25], v72 offset:20480
    ds_read_b64_tr_b16 v[26:27], v72 offset:21504
    ds_read_b64_tr_b16 v[28:29], v73 offset:20480
    ds_read_b64_tr_b16 v[30:31], v73 offset:21504
    s_waitcnt lgkmcnt(5)
    v_mfma_f32_32x32x16_bf16 v[48:63], v[20:23], v[112:115], v[48:63]
    s_setprio 0
    v_lshlrev_b32 v93, 7, v93
    v_bfe_u32 v94, v0, 4, 1
    v_lshl_add_u32 v93, v94, 5, v93
    v_and_b32 v94, 3, v0
    v_lshl_add_u32 v93, v94, 3, v93
    s_and_b32 s4, s36, 1
    s_lshl_b32 s4, s4, 6
    s_and_b32 s5, s36, 2
    s_lshl_b32 s5, s5, 13
    s_add_u32 s4, s4, s5
    s_add_u32 s4, s4, 131072
    v_add_u32 v94, s4, v93
    s_add_u32 m0, s45, 114688
    s_mul_i32 s43, s42, 1920
    buffer_load_dwordx4 v66, s[12:15], s43 offen  lds
    s_add_u32 m0, s45, 148480
    s_add_u32 s49, s49, 24576
    buffer_load_dwordx4 v95, s[28:31], s49 offen lds
    s_setprio 1
    s_waitcnt lgkmcnt(2)
    v_mfma_f32_32x32x16_bf16 v[32:47], v[24:27], v[116:119], v[32:47]
    ds_read_b128 v[120:123], v70 offset:16384
    ds_read_b64_tr_b16 v[16:17], v72 offset:24576
    ds_read_b64_tr_b16 v[18:19], v72 offset:25600
    ds_read_b64_tr_b16 v[20:21], v73 offset:24576
    ds_read_b64_tr_b16 v[22:23], v73 offset:25600
    s_waitcnt lgkmcnt(5)
    v_mfma_f32_32x32x16_bf16 v[48:63], v[28:31], v[116:119], v[48:63]
    s_setprio 0
    s_mov_b32 s4, 0x00100001
    s_mov_b32 s5, s4
    v_mov_b32 v85, 0x3f803f80
    v_cndmask_b32 v84, 0, v85, s[4:5]
    v_mov_b32 v85, v84
    v_mov_b32 v86, v84
    v_mov_b32 v87, v84
    s_add_u32 m0, s45, 115712
    s_nop 0
    buffer_load_dwordx4 v67, s[12:15], s43 offen  lds
    s_add_u32 m0, s45, 131072
    s_nop 0
    buffer_load_dwordx4 v92, s[12:15], s34 offen lds
    ds_read_b128 v[124:127], v71 offset:16384
    ds_read_b64_tr_b16 v[24:25], v72 offset:28672
    ds_read_b64_tr_b16 v[26:27], v72 offset:29696
    ds_read_b64_tr_b16 v[28:29], v73 offset:28672
    ds_read_b64_tr_b16 v[30:31], v73 offset:29696
    s_setprio 1
    s_waitcnt lgkmcnt(7)
    v_mfma_f32_32x32x16_bf16 v[32:47], v[16:19], v[120:123], v[32:47]
    s_add_u32 m0, s45, 0
    s_add_u32 s42, s42, 128
    s_cmp_eq_u32 s42, 1280
    s_cselect_b32 s42, 0, s42
    buffer_load_dwordx4 v64, s[8:11], s42 offen  lds
    s_add_u32 m0, s45, 132096
    s_add_u32 s34, s34, 30720
    buffer_load_dwordx4 v92, s[12:15], s34 offen lds
    s_waitcnt lgkmcnt(5)
    v_mfma_f32_32x32x16_bf16 v[48:63], v[20:23], v[120:123], v[48:63]
    s_cmp_ge_u32 s36, 4
    s_cbranch_scc1 F_cq1r
    s_cmp_eq_u32 s36, 1
    s_cbranch_scc1 F_cq1w1
    s_cmp_eq_u32 s36, 2
    s_cbranch_scc1 F_cq1w2
    s_cmp_eq_u32 s36, 3
    s_cbranch_scc1 F_cq1w3
    s_call_b64 s[6:7], F_pg6
    s_branch F_cq1r
F_cq1w1:
    s_call_b64 s[6:7], F_pg7
    s_branch F_cq1r
F_cq1w2:
    s_call_b64 s[6:7], F_pg8
    s_branch F_cq1r
F_cq1w3:
    s_call_b64 s[6:7], F_ps
F_cq1r:
    s_waitcnt lgkmcnt(0)
    s_waitcnt vmcnt(11)
    s_barrier
    v_mfma_f32_32x32x16_bf16 v[32:47], v[24:27], v[124:127], v[32:47]
    ds_read_b128 v[128:131], v68 offset:32768
    ds_read_b64_tr_b16 v[16:17], v72 offset:32768
    ds_read_b64_tr_b16 v[18:19], v72 offset:33792
    ds_read_b64_tr_b16 v[20:21], v73 offset:32768
    ds_read_b64_tr_b16 v[22:23], v73 offset:33792
    v_mfma_f32_32x32x16_bf16 v[48:63], v[28:31], v[124:127], v[48:63]
    s_branch F_pg1k
.p2align 12
F_pg1:
    s_setpc_b64 s[6:7]
F_pg1k:
    s_setprio 0
    s_waitcnt vmcnt(10)
    v_lshlrev_b32 v81, 16, v74
    v_and_b32 v82, 0xffff0000, v74
    v_add_f32 v79, v81, v82
    v_mul_f32 v80, v81, v81
    v_fmac_f32 v80, v82, v82
    v_lshlrev_b32 v81, 16, v75
    v_and_b32 v82, 0xffff0000, v75
    v_add_f32 v79, v79, v81
    v_fmac_f32 v80, v81, v81
    v_add_f32 v79, v79, v82
    v_fmac_f32 v80, v82, v82
    v_lshlrev_b32 v81, 16, v76
    v_and_b32 v82, 0xffff0000, v76
    s_add_u32 m0, s45, 1024
    s_nop 0
    buffer_load_dwordx4 v65, s[8:11], s42 offen  lds
    s_setprio 1
    s_waitcnt lgkmcnt(2)
    v_mfma_f32_32x32x16_bf16 v[32:47], v[16:19], v[128:131], v[32:47]
    ds_read_b128 v[132:135], v69 offset:32768
    ds_read_b64_tr_b16 v[24:25], v72 offset:36864
    ds_read_b64_tr_b16 v[26:27], v72 offset:37888
    ds_read_b64_tr_b16 v[28:29], v73 offset:36864
    ds_read_b64_tr_b16 v[30:31], v73 offset:37888
    s_waitcnt lgkmcnt(5)
    v_mfma_f32_32x32x16_bf16 v[48:63], v[20:23], v[128:131], v[48:63]
    s_setprio 0
    v_add_f32 v79, v79, v81
    v_fmac_f32 v80, v81, v81
    v_add_f32 v79, v79, v82
    v_fmac_f32 v80, v82, v82
    v_lshlrev_b32 v81, 16, v77
    v_and_b32 v82, 0xffff0000, v77
    v_add_f32 v79, v79, v81
    v_fmac_f32 v80, v81, v81
    v_add_f32 v79, v79, v82
    v_fmac_f32 v80, v82, v82
    s_waitcnt vmcnt(10)
    v_lshlrev_b32 v81, 16, v78
    v_and_b32 v82, 0xffff0000, v78
    v_add_f32 v79, v79, v81
    s_add_u32 m0, s45, 65536
    s_mul_i32 s43, s42, 1920
    buffer_load_dwordx4 v66, s[12:15], s43 offen  lds
    s_setprio 1
    s_waitcnt lgkmcnt(2)
    v_mfma_f32_32x32x16_bf16 v[32:47], v[24:27], v[132:135], v[32:47]
    ds_read_b128 v[136:139], v70 offset:32768
    ds_read_b64_tr_b16 v[16:17], v72 offset:40960
    ds_read_b64_tr_b16 v[18:19], v72 offset:41984
    ds_read_b64_tr_b16 v[20:21], v73 offset:40960
    ds_read_b64_tr_b16 v[22:23], v73 offset:41984
    s_waitcnt lgkmcnt(5)
    v_mfma_f32_32x32x16_bf16 v[48:63], v[28:31], v[132:135], v[48:63]
    s_setprio 0
    v_mov_b32 v252, 0
    global_load_dwordx2 v[252:253], v252, s[72:73] sc1
    v_fmac_f32 v80, v81, v81
    v_add_f32 v79, v79, v82
    v_fmac_f32 v80, v82, v82
    s_nop 0
    v_add_f32_dpp v79, v79, v79 row_shr:1 row_mask:0xf bank_mask:0xf bound_ctrl:0
    v_add_f32_dpp v80, v80, v80 row_shr:1 row_mask:0xf bank_mask:0xf bound_ctrl:0
    s_nop 0
    v_add_f32_dpp v79, v79, v79 row_shr:2 row_mask:0xf bank_mask:0xf bound_ctrl:0
    v_add_f32_dpp v80, v80, v80 row_shr:2 row_mask:0xf bank_mask:0xf bound_ctrl:0
    s_nop 0
    v_add_f32_dpp v79, v79, v79 row_shr:4 row_mask:0xf bank_mask:0xf bound_ctrl:0
    v_add_f32_dpp v80, v80, v80 row_shr:4 row_mask:0xf bank_mask:0xf bound_ctrl:0
    s_add_u32 m0, s45, 66560
    s_nop 0
    buffer_load_dwordx4 v67, s[12:15], s43 offen  lds
    ds_read_b128 v[140:143], v71 offset:32768
    ds_read_b64_tr_b16 v[24:25], v72 offset:45056
    ds_read_b64_tr_b16 v[26:27], v72 offset:46080
    ds_read_b64_tr_b16 v[28:29], v73 offset:45056
    ds_read_b64_tr_b16 v[30:31], v73 offset:46080
    s_setprio 1
    s_waitcnt lgkmcnt(7)
    v_mfma_f32_32x32x16_bf16 v[32:47], v[16:19], v[136:139], v[32:47]
    v_add_f32_dpp v79, v79, v79 row_shr:8 row_mask:0xf bank_mask:0xf bound_ctrl:0
    v_add_f32_dpp v80, v80, v80 row_shr:8 row_mask:0xf bank_mask:0xf bound_ctrl:0
    s_add_u32 m0, s45, 16384
    s_add_u32 s42, s42, 128
    s_cmp_eq_u32 s42, 1280
    s_cselect_b32 s42, 0, s42
    buffer_load_dwordx4 v64, s[8:11], s42 offen  lds
    s_waitcnt lgkmcnt(5)
    v_mfma_f32_32x32x16_bf16 v[48:63], v[20:23], v[136:139], v[48:63]
    s_waitcnt lgkmcnt(0)
    s_waitcnt vmcnt(8)
    s_waitcnt vmcnt(5)
    s_barrier
    v_mfma_f32_32x32x16_bf16 v[32:47], v[24:27], v[140:143], v[32:47]
    ds_read_b128 v[144:147], v68 offset:49152
    ds_read_b64_tr_b16 v[16:17], v72 offset:49152
    ds_read_b64_tr_b16 v[18:19], v72 offset:50176
    ds_read_b64_tr_b16 v[20:21], v73 offset:49152
    ds_read_b64_tr_b16 v[22:23], v73 offset:50176
    v_mfma_f32_32x32x16_bf16 v[48:63], v[28:31], v[140:143], v[48:63]
    s_setprio 0
    s_cmp_lt_u32 s36, 4
    s_cbranch_scc1 F_ifw9
    ds_read_b64_tr_b16 v[236:237], v94 offset:0
    ds_read_b64_tr_b16 v[238:239], v94 offset:512
    ds_read_b64_tr_b16 v[240:241], v94 offset:2048
    ds_read_b64_tr_b16 v[242:243], v94 offset:2560
    ds_read_b64_tr_b16 v[244:245], v94 offset:4096
    ds_read_b64_tr_b16 v[246:247], v94 offset:4608
    ds_read_b64_tr_b16 v[248:249], v94 offset:6144
    ds_read_b64_tr_b16 v[250:251], v94 offset:6656
F_ifw9:
    v_add_f32_dpp v79, v79, v79 row_bcast:15 row_mask:0xa bank_mask:0xf
    v_add_f32_dpp v80, v80, v80 row_bcast:15 row_mask:0xa bank_mask:0xf
    s_nop 0
    v_add_f32_dpp v79, v79, v79 row_bcast:31 row_mask:0xc bank_mask:0xf
    v_add_f32_dpp v80, v80, v80 row_bcast:31 row_mask:0xc bank_mask:0xf
    s_add_u32 m0, s45, 17408
    s_nop 0
    buffer_load_dwordx4 v65, s[8:11], s42 offen  lds
    s_setprio 1
    s_waitcnt lgkmcnt(2)
    v_mfma_f32_32x32x16_bf16 v[32:47], v[16:19], v[144:147], v[32:47]
    ds_read_b128 v[148:151], v69 offset:49152
    ds_read_b64_tr_b16 v[24:25], v72 offset:53248
    ds_read_b64_tr_b16 v[26:27], v72 offset:54272
    ds_read_b64_tr_b16 v[28:29], v73 offset:53248
    ds_read_b64_tr_b16 v[30:31], v73 offset:54272
    s_waitcnt lgkmcnt(5)
    v_mfma_f32_32x32x16_bf16 v[48:63], v[20:23], v[144:147], v[48:63]
    s_setprio 0
    s_add_u32 m0, s45, 81920
    s_mul_i32 s43, s42, 1920
    buffer_load_dwordx4 v66, s[12:15], s43 offen  lds
    s_cmp_lt_u32 s36, 4
    s_cbranch_scc1 F_ifw10
    s_waitcnt lgkmcnt(0)
    v_mfma_f32_16x16x32_bf16 v[88:91], v[84:87], v[236:239], 0
    v_mfma_f32_16x16x32_bf16 v[88:91], v[84:87], v[240:243], v[88:91]
    v_mfma_f32_16x16x32_bf16 v[88:91], v[84:87], v[244:247], v[88:91]
    v_mfma_f32_16x16x32_bf16 v[88:91], v[84:87], v[248:251], v[88:91]
    ds_read_b64_tr_b16 v[236:237], v94 offset:8192
    ds_read_b64_tr_b16 v[238:239], v94 offset:8704
    ds_read_b64_tr_b16 v[240:241], v94 offset:10240
    ds_read_b64_tr_b16 v[242:243], v94 offset:10752
    ds_read_b64_tr_b16 v[244:245], v94 offset:12288
    ds_read_b64_tr_b16 v[246:247], v94 offset:12800
    ds_read_b64_tr_b16 v[248:249], v94 offset:14336
    ds_read_b64_tr_b16 v[250:251], v94 offset:14848
F_ifw10:
    s_setprio 1
    s_waitcnt lgkmcnt(2)
    v_mfma_f32_32x32x16_bf16 v[32:47], v[24:27], v[148:151], v[32:47]
    ds_read_b128 v[152:155], v70 offset:49152
    ds_read_b64_tr_b16 v[16:17], v72 offset:57344
    ds_read_b64_tr_b16 v[18:19], v72 offset:58368
    ds_read_b64_tr_b16 v[20:21], v73 offset:57344
    ds_read_b64_tr_b16 v[22:23], v73 offset:58368
    s_waitcnt lgkmcnt(5)
    v_mfma_f32_32x32x16_bf16 v[48:63], v[28:31], v[148:151], v[48:63]
    s_setprio 0
    s_add_u32 m0, s45, 82944
    s_nop 0
    buffer_load_dwordx4 v67, s[12:15], s43 offen  lds
    s_cmp_lt_u32 s36, 4
    s_cbranch_scc1 F_ifw11
    s_waitcnt lgkmcnt(0)
    v_mfma_f32_16x16x32_bf16 v[88:91], v[84:87], v[236:239], v[88:91]
    v_mfma_f32_16x16x32_bf16 v[88:91], v[84:87], v[240:243], v[88:91]
    v_mfma_f32_16x16x32_bf16 v[88:91], v[84:87], v[244:247], v[88:91]
    v_mfma_f32_16x16x32_bf16 v[88:91], v[84:87], v[248:251], v[88:91]
    s_nop 7
    v_lshlrev_b32 v89, 2, v0
    s_mov_b64 exec, 0xffffffff
    buffer_store_dword v88, v89, s[24:27], s53 offen sc0 sc1
    s_mov_b64 exec, -1
F_ifw11:
    v_mul_f32 v79, 0x3acccccd, v79
    v_mul_f32 v80, 0x3acccccd, v80
    v_fma_f32 v80, -v79, v79, v80
    v_max_f32 v80, 0, v80
    ds_read_b128 v[156:159], v71 offset:49152
    ds_read_b64_tr_b16 v[24:25], v72 offset:61440
    ds_read_b64_tr_b16 v[26:27], v72 offset:62464
    ds_read_b64_tr_b16 v[28:29], v73 offset:61440
    ds_read_b64_tr_b16 v[30:31], v73 offset:62464
    s_setprio 1
    s_waitcnt lgkmcnt(7)
    v_mfma_f32_32x32x16_bf16 v[32:47], v[16:19], v[152:155], v[32:47]
    s_add_u32 m0, s45, 32768
    s_add_u32 s42, s42, 128
    s_cmp_eq_u32 s42, 1280
    s_cselect_b32 s42, 0, s42
    buffer_load_dwordx4 v64, s[8:11], s42 offen  lds
    v_cvt_pk_bf16_f32 v83, -v79, -v79
    v_cvt_pk_bf16_f32 v80, v80, v80
    v_lshlrev_b32 v80, 16, v80
    s_waitcnt lgkmcnt(5)
    v_mfma_f32_32x32x16_bf16 v[48:63], v[20:23], v[152:155], v[48:63]
    s_waitcnt lgkmcnt(0)
    s_waitcnt vmcnt(5)
    s_barrier
    v_mfma_f32_32x32x16_bf16 v[32:47], v[24:27], v[156:159], v[32:47]
    ds_read_b128 v[160:163], v68 offset:0
    ds_read_b64_tr_b16 v[16:17], v72 offset:0
    ds_read_b64_tr_b16 v[18:19], v72 offset:1024
    ds_read_b64_tr_b16 v[20:21], v73 offset:0
    ds_read_b64_tr_b16 v[22:23], v73 offset:1024
    v_mfma_f32_32x32x16_bf16 v[48:63], v[28:31], v[156:159], v[48:63]
    s_setprio 0
    s_add_u32 m0, s45, 33792
    s_nop 0
    buffer_load_dwordx4 v65, s[8:11], s42 offen  lds
    v_add_f32 v80, 0x3727c5ac, v80
    v_cvt_pk_bf16_f32 v80, v80, v80
    v_lshlrev_b32 v80, 16, v80
    v_sqrt_f32 v80, v80
    s_nop 0
    v_cvt_pk_bf16_f32 v80, v80, v80
    v_lshlrev_b32 v80, 16, v80
    v_rcp_f32 v82, v80
    s_mov_b32 s4, 0
    s_brev_b32 s5, 1
    s_mov_b64 exec, s[4:5]
    buffer_store_dwordx2 v[82:83], off, s[24:27], s54 sc0 sc1
    s_mov_b64 exec, -1
    s_setprio 1
    s_waitcnt lgkmcnt(2)
    v_mfma_f32_32x32x16_bf16 v[32:47], v[16:19], v[160:163], v[32:47]
    ds_read_b128 v[164:167], v69 offset:0
    ds_read_b64_tr_b16 v[24:25], v72 offset:4096
    ds_read_b64_tr_b16 v[26:27], v72 offset:5120
    ds_read_b64_tr_b16 v[28:29], v73 offset:4096
    ds_read_b64_tr_b16 v[30:31], v73 offset:5120
    s_waitcnt lgkmcnt(5)
    v_mfma_f32_32x32x16_bf16 v[48:63], v[20:23], v[160:163], v[48:63]
    s_setprio 0
    s_add_u32 m0, s45, 98304
    s_mul_i32 s43, s42, 1920
    buffer_load_dwordx4 v66, s[12:15], s43 offen  lds
    s_mov_b32 s16, s64
    s_and_b32 s17, s65, 0xffff
    s_mov_b32 s18, 1966080
    s_mov_b32 s19, 0x00020000
    s_mov_b32 s20, s66
    s_and_b32 s21, s67, 0xffff
    s_mov_b32 s22, 1966080
    s_mov_b32 s23, 0x00020000
    v_lshrrev_b32 v13, 5, v0
    s_setprio 1
    s_waitcnt lgkmcnt(2)
    v_mfma_f32_32x32x16_bf16 v[32:47], v[24:27], v[164:167], v[32:47]
    ds_read_b128 v[168:171], v70 offset:0
    ds_read_b64_tr_b16 v[16:17], v72 offset:8192
    ds_read_b64_tr_b16 v[18:19], v72 offset:9216
    ds_read_b64_tr_b16 v[20:21], v73 offset:8192
    ds_read_b64_tr_b16 v[22:23], v73 offset:9216
    s_waitcnt lgkmcnt(5)
    v_mfma_f32_32x32x16_bf16 v[48:63], v[28:31], v[164:167], v[48:63]
    s_setprio 0
    s_add_u32 m0, s45, 99328
    s_nop 0
    buffer_load_dwordx4 v67, s[12:15], s43 offen  lds
    v_bfe_u32 v12, v0, 2, 2
    v_lshl_add_u32 v14, v13, 3, v12
    v_bfe_u32 v15, v0, 4, 1
    v_and_b32 v12, 3, v0
    v_lshlrev_b32 v4, 7, v14
    ds_read_b128 v[172:175], v71 offset:0
    ds_read_b64_tr_b16 v[24:25], v72 offset:12288
    ds_read_b64_tr_b16 v[26:27], v72 offset:13312
    ds_read_b64_tr_b16 v[28:29], v73 offset:12288
    ds_read_b64_tr_b16 v[30:31], v73 offset:13312
    s_setprio 1
    s_waitcnt lgkmcnt(7)
    v_mfma_f32_32x32x16_bf16 v[32:47], v[16:19], v[168:171], v[32:47]
    s_add_u32 m0, s45, 49152
    s_add_u32 s42, s42, 128
    s_cmp_eq_u32 s42, 1280
    s_cselect_b32 s42, 0, s42
    buffer_load_dwordx4 v64, s[8:11], s42 offen  lds
    s_waitcnt lgkmcnt(5)
    v_mfma_f32_32x32x16_bf16 v[48:63], v[20:23], v[168:171], v[48:63]
    s_waitcnt lgkmcnt(0)
    s_waitcnt vmcnt(6)
    s_barrier
    v_mfma_f32_32x32x16_bf16 v[32:47], v[24:27], v[172:175], v[32:47]
    ds_read_b128 v[176:179], v68 offset:16384
    ds_read_b64_tr_b16 v[16:17], v72 offset:16384
    ds_read_b64_tr_b16 v[18:19], v72 offset:17408
    ds_read_b64_tr_b16 v[20:21], v73 offset:16384
    ds_read_b64_tr_b16 v[22:23], v73 offset:17408
    v_mfma_f32_32x32x16_bf16 v[48:63], v[28:31], v[172:175], v[48:63]
    s_setprio 0
    s_add_u32 m0, s45, 50176
    s_nop 0
    buffer_load_dwordx4 v65, s[8:11], s42 offen  lds
    v_lshl_add_u32 v4, v15, 16, v4
    v_lshl_add_u32 v4, v12, 3, v4
    v_bfe_u32 v12, v0, 3, 1
    v_lshlrev_b32 v12, 1, v12
    v_xor_b32 v12, v12, v15
    s_setprio 1
    s_waitcnt lgkmcnt(2)
    v_mfma_f32_32x32x16_bf16 v[32:47], v[16:19], v[176:179], v[32:47]
    ds_read_b128 v[180:183], v69 offset:16384
    ds_read_b64_tr_b16 v[24:25], v72 offset:20480
    ds_read_b64_tr_b16 v[26:27], v72 offset:21504
    ds_read_b64_tr_b16 v[28:29], v73 offset:20480
    ds_read_b64_tr_b16 v[30:31], v73 offset:21504
    s_waitcnt lgkmcnt(5)
    v_mfma_f32_32x32x16_bf16 v[48:63], v[20:23], v[176:179], v[48:63]
    s_setprio 0
    s_add_u32 m0, s45, 114688
    s_mul_i32 s43, s42, 1920
    buffer_load_dwordx4 v66, s[12:15], s43 offen  lds
    v_readfirstlane_b32 s32, v252
    v_readfirstlane_b32 s33, v253
    s_cmp_eq_u32 s32, 0
    s_cbranch_scc1 F_nspin6
F_nz5:
    s_lshl_b32 s4, s38, 1
    v_xor_b32 v12, s4, v12
    v_lshl_add_u32 v4, v12, 5, v4
    s_setprio 1
    s_waitcnt lgkmcnt(2)
    v_mfma_f32_32x32x16_bf16 v[32:47], v[24:27], v[180:183], v[32:47]
    ds_read_b128 v[184:187], v70 offset:16384
    ds_read_b64_tr_b16 v[16:17], v72 offset:24576
    ds_read_b64_tr_b16 v[18:19], v72 offset:25600
    ds_read_b64_tr_b16 v[20:21], v73 offset:24576
    ds_read_b64_tr_b16 v[22:23], v73 offset:25600
    s_waitcnt lgkmcnt(5)
    v_mfma_f32_32x32x16_bf16 v[48:63], v[28:31], v[180:183], v[48:63]
    s_setprio 0
    s_add_u32 m0, s45, 115712
    s_nop 0
    buffer_load_dwordx4 v67, s[12:15], s43 offen  lds
    v_xor_b32 v5, 32, v4
    v_lshrrev_b32 v12, 3, v0
    s_lshl_b32 s4, s36, 3
    v_add_u32 v12, s4, v12
    v_mul_u32_u24 v12, 3072, v12
    ds_read_b128 v[188:191], v71 offset:16384
    ds_read_b64_tr_b16 v[24:25], v72 offset:28672
    ds_read_b64_tr_b16 v[26:27], v72 offset:29696
    ds_read_b64_tr_b16 v[28:29], v73 offset:28672
    ds_read_b64_tr_b16 v[30:31], v73 offset:29696
    s_setprio 1
    s_waitcnt lgkmcnt(7)
    v_mfma_f32_32x32x16_bf16 v[32:47], v[16:19], v[184:187], v[32:47]
    s_add_u32 m0, s45, 0
    s_add_u32 s42, s42, 128
    s_cmp_eq_u32 s42, 1280
    s_cselect_b32 s42, 0, s42
    buffer_load_dwordx4 v64, s[8:11], s42 offen  lds
    s_waitcnt lgkmcnt(5)
    v_mfma_f32_32x32x16_bf16 v[48:63], v[20:23], v[184:187], v[48:63]
    s_waitcnt lgkmcnt(0)
    s_waitcnt vmcnt(5)
    s_waitcnt vmcnt(7)
    s_waitcnt vmcnt(10)
    s_barrier
    v_mfma_f32_32x32x16_bf16 v[32:47], v[24:27], v[188:191], v[32:47]
    ds_read_b128 v[192:195], v68 offset:32768
    ds_read_b64_tr_b16 v[16:17], v72 offset:32768
    ds_read_b64_tr_b16 v[18:19], v72 offset:33792
    ds_read_b64_tr_b16 v[20:21], v73 offset:32768
    ds_read_b64_tr_b16 v[22:23], v73 offset:33792
    v_mfma_f32_32x32x16_bf16 v[48:63], v[28:31], v[188:191], v[48:63]
    s_setprio 0
    s_add_u32 m0, s45, 1024
    s_nop 0
    buffer_load_dwordx4 v65, s[8:11], s42 offen  lds
    s_cmp_lg_u32 s36, 0
    s_cbranch_scc1 F_pub12
    s_lshl_b32 s4, s2, 5
    s_add_u32 s4, s4, 19678848
    s_add_u32 s5, s32, 1
    v_mov_b32 v24, s5
    v_mov_b32 v25, s33
    s_mov_b64 exec, 1
    buffer_store_dwordx2 v[24:25], off, s[24:27], s4 sc0 sc1
    s_mov_b64 exec, -1
F_pub12:
    s_setprio 1
    s_waitcnt lgkmcnt(2)
    v_mfma_f32_32x32x16_bf16 v[32:47], v[16:19], v[192:195], v[32:47]
    ds_read_b128 v[196:199], v69 offset:32768
    ds_read_b64_tr_b16 v[24:25], v72 offset:36864
    ds_read_b64_tr_b16 v[26:27], v72 offset:37888
    ds_read_b64_tr_b16 v[28:29], v73 offset:36864
    ds_read_b64_tr_b16 v[30:31], v73 offset:37888
    s_waitcnt lgkmcnt(5)
    v_mfma_f32_32x32x16_bf16 v[48:63], v[20:23], v[192:195], v[48:63]
    s_setprio 0
    s_add_u32 m0, s45, 65536
    s_mul_i32 s43, s42, 1920
    buffer_load_dwordx4 v66, s[12:15], s43 offen  lds
    s_mul_i32 s47, s40, 192
    s_and_b32 s5, s40, 1
    s_lshl_b32 s46, s5, 6
    s_add_u32 s46, s46, s47
    v_add_u32 v12, s46, v12
    s_andn2_b32 s5, 1, s40
    s_lshl_b32 s5, s5, 7
    s_add_u32 s47, s47, s5
    v_lshlrev_b32 v15, 2, v15
    s_setprio 1
    s_waitcnt lgkmcnt(2)
    v_mfma_f32_32x32x16_bf16 v[32:47], v[24:27], v[196:199], v[32:47]
    ds_read_b128 v[200:203], v70 offset:32768
    ds_read_b64_tr_b16 v[16:17], v72 offset:40960
    ds_read_b64_tr_b16 v[18:19], v72 offset:41984
    ds_read_b64_tr_b16 v[20:21], v73 offset:40960
    ds_read_b64_tr_b16 v[22:23], v73 offset:41984
    s_waitcnt lgkmcnt(5)
    v_mfma_f32_32x32x16_bf16 v[48:63], v[28:31], v[196:199], v[48:63]
    s_setprio 0
    s_add_u32 m0, s45, 66560
    s_nop 0
    buffer_load_dwordx4 v67, s[12:15], s43 offen  lds
    v_and_b32 v14, 7, v0
    v_xor_b32 v14, v14, v15
    v_lshl_add_u32 v2, v14, 4, v12
    v_xor_b32 v14, 2, v14
    v_lshl_add_u32 v3, v14, 4, v12
    s_mul_i32 s44, s3, 196608
    ds_read_b128 v[204:207], v71 offset:32768
    ds_read_b64_tr_b16 v[24:25], v72 offset:45056
    ds_read_b64_tr_b16 v[26:27], v72 offset:46080
    ds_read_b64_tr_b16 v[28:29], v73 offset:45056
    ds_read_b64_tr_b16 v[30:31], v73 offset:46080
    s_setprio 1
    s_waitcnt lgkmcnt(7)
    v_mfma_f32_32x32x16_bf16 v[32:47], v[16:19], v[200:203], v[32:47]
    s_add_u32 m0, s45, 16384
    s_add_u32 s42, s42, 128
    s_cmp_eq_u32 s42, 1280
    s_cselect_b32 s42, 0, s42
    buffer_load_dwordx4 v64, s[8:11], s42 offen  lds
    s_waitcnt lgkmcnt(5)
    v_mfma_f32_32x32x16_bf16 v[48:63], v[20:23], v[200:203], v[48:63]
    s_waitcnt lgkmcnt(0)
    s_waitcnt vmcnt(5)
    s_barrier
    v_mfma_f32_32x32x16_bf16 v[32:47], v[24:27], v[204:207], v[32:47]
    ds_read_b128 v[208:211], v68 offset:49152
    ds_read_b64_tr_b16 v[16:17], v72 offset:49152
    ds_read_b64_tr_b16 v[18:19], v72 offset:50176
    ds_read_b64_tr_b16 v[20:21], v73 offset:49152
    ds_read_b64_tr_b16 v[22:23], v73 offset:50176
    v_mfma_f32_32x32x16_bf16 v[48:63], v[28:31], v[204:207], v[48:63]
    s_setprio 0
    s_add_u32 m0, s45, 17408
    s_nop 0
    buffer_load_dwordx4 v65, s[8:11], s42 offen  lds
    s_lshl_b32 s48, s39, 2
    s_add_u32 s48, s48, s37
    s_lshl_b32 s4, s36, 10
    s_add_u32 s4, s4, 19678848
    v_and_b32 v12, 31, v0
    v_lshl_add_u32 v11, v12, 5, s4
    s_lshl_b32 s4, s38, 1
    s_add_u32 s4, s4, s41
    s_lshl_b32 s4, s4, 17
    s_add_u32 s75, s4, 0
    s_setprio 1
    s_waitcnt lgkmcnt(2)
    v_mfma_f32_32x32x16_bf16 v[32:47], v[16:19], v[208:211], v[32:47]
    ds_read_b128 v[212:215], v69 offset:49152
    ds_read_b64_tr_b16 v[24:25], v72 offset:53248
    ds_read_b64_tr_b16 v[26:27], v72 offset:54272
    ds_read_b64_tr_b16 v[28:29], v73 offset:53248
    ds_read_b64_tr_b16 v[30:31], v73 offset:54272
    s_waitcnt lgkmcnt(5)
    v_mfma_f32_32x32x16_bf16 v[48:63], v[20:23], v[208:211], v[48:63]
    s_setprio 0
    s_add_u32 m0, s45, 81920
    s_mul_i32 s43, s42, 1920
    buffer_load_dwordx4 v66, s[12:15], s43 offen  lds
    s_cmp_lt_u32 s40, 5
    s_cselect_b32 s49, 0x3ea52b5c, 1.0
    s_lshl_b32 s4, s48, 5
    v_add_u32 v12, s4, v12
    v_lshlrev_b32 v12, 4, v12
    v_lshl_add_u32 v10, v13, 15, v12
    s_setprio 1
    s_waitcnt lgkmcnt(2)
    v_mfma_f32_32x32x16_bf16 v[32:47], v[24:27], v[212:215], v[32:47]
    ds_read_b128 v[216:219], v70 offset:49152
    ds_read_b64_tr_b16 v[16:17], v72 offset:57344
    ds_read_b64_tr_b16 v[18:19], v72 offset:58368
    ds_read_b64_tr_b16 v[20:21], v73 offset:57344
    ds_read_b64_tr_b16 v[22:23], v73 offset:58368
    s_waitcnt lgkmcnt(5)
    v_mfma_f32_32x32x16_bf16 v[48:63], v[28:31], v[212:215], v[48:63]
    s_setprio 0
    s_add_u32 m0, s45, 82944
    s_nop 0
    buffer_load_dwordx4 v67, s[12:15], s43 offen  lds
    s_add_u32 m0, s55, 32768
    s_add_u32 s44, s44, 196608
    s_cmp_eq_u32 s44, 1966080
    s_cselect_b32 s44, 0, s44
    buffer_load_dwordx4 v2, s[16:19], s44 offen  lds
    ds_read_b128 v[220:223], v71 offset:49152
    ds_read_b64_tr_b16 v[24:25], v72 offset:61440
    ds_read_b64_tr_b16 v[26:27], v72 offset:62464
    ds_read_b64_tr_b16 v[28:29], v73 offset:61440
    ds_read_b64_tr_b16 v[30:31], v73 offset:62464
    s_setprio 1
    s_waitcnt lgkmcnt(7)
    v_mfma_f32_32x32x16_bf16 v[32:47], v[16:19], v[216:219], v[32:47]
    s_add_u32 m0, s55, 98304
    s_nop 0
    buffer_load_dwordx4 v3, s[20:23], s44 offen  lds
    s_waitcnt lgkmcnt(5)
    v_mfma_f32_32x32x16_bf16 v[48:63], v[20:23], v[216:219], v[48:63]
    s_waitcnt lgkmcnt(0)
    s_waitcnt vmcnt(6)
    s_barrier
    v_mfma_f32_32x32x16_bf16 v[32:47], v[24:27], v[220:223], v[32:47]
    ds_read_b128 v[224:227], v68 offset:0
    ds_read_b64_tr_b16 v[16:17], v72 offset:0
    ds_read_b64_tr_b16 v[18:19], v72 offset:1024
    ds_read_b64_tr_b16 v[20:21], v73 offset:0
    ds_read_b64_tr_b16 v[22:23], v73 offset:1024
    v_mfma_f32_32x32x16_bf16 v[48:63], v[28:31], v[220:223], v[48:63]
    s_setprio 0
    s_cmp_ge_u32 s36, 4
    s_cbranch_scc1 F_ifw13
    s_lshl_b32 s4, s36, 6
    v_add_u32 v12, s4, v0
    v_lshrrev_b32 v13, 5, v12
    v_mul_u32_u24 v13, 19456, v13
    v_lshl_add_u32 v13, v12, 4, v13
F_ifw13:
    s_cmp_lt_u32 s36, 4
    s_cbranch_scc1 F_ifw14
    s_lshl_b32 s4, s37, 6
    v_add_u32 v12, s4, v0
    v_mul_u32_u24 v13, 2731, v12
    v_lshrrev_b32 v13, 16, v13
    v_lshrrev_b32 v14, 1, v13
F_ifw14:
    s_setprio 1
    s_waitcnt lgkmcnt(2)
    v_mfma_f32_32x32x16_bf16 v[32:47], v[16:19], v[224:227], v[32:47]
    ds_read_b128 v[228:231], v69 offset:0
    ds_read_b64_tr_b16 v[24:25], v72 offset:4096
    ds_read_b64_tr_b16 v[26:27], v72 offset:5120
    ds_read_b64_tr_b16 v[28:29], v73 offset:4096
    ds_read_b64_tr_b16 v[30:31], v73 offset:5120
    s_waitcnt lgkmcnt(5)
    v_mfma_f32_32x32x16_bf16 v[48:63], v[20:23], v[224:227], v[48:63]
    s_setprio 0
    s_add_u32 m0, s55, 40960
    s_add_u32 s44, s44, 196608
    s_cmp_eq_u32 s44, 1966080
    s_cselect_b32 s44, 0, s44
    buffer_load_dwordx4 v2, s[16:19], s44 offen  lds
    s_cmp_ge_u32 s36, 4
    s_cbranch_scc1 F_ifw15
    s_lshl_b32 s4, s41, 7
    s_add_u32 s4, s4, 19578880
    v_add_u32 v13, s4, v13
    s_lshl_b32 s4, s39, 10
    s_add_u32 s4, s4, 19559936
    v_lshl_add_u32 v14, v12, 4, s4
F_ifw15:
    s_cmp_lt_u32 s36, 4
    s_cbranch_scc1 F_ifw16
    v_mul_u32_u24 v14, 7680, v14
    v_mul_u32_u24 v13, 5760, v13
    v_add_u32 v13, v13, v14
    v_lshl_add_u32 v13, v12, 4, v13
F_ifw16:
    s_setprio 1
    s_waitcnt lgkmcnt(2)
    v_mfma_f32_32x32x16_bf16 v[32:47], v[24:27], v[228:231], v[32:47]
    ds_read_b128 v[232:235], v70 offset:0
    ds_read_b64_tr_b16 v[16:17], v72 offset:8192
    ds_read_b64_tr_b16 v[18:19], v72 offset:9216
    ds_read_b64_tr_b16 v[20:21], v73 offset:8192
    ds_read_b64_tr_b16 v[22:23], v73 offset:9216
    s_waitcnt lgkmcnt(5)
    v_mfma_f32_32x32x16_bf16 v[48:63], v[28:31], v[228:231], v[48:63]
    s_setprio 0
    s_add_u32 m0, s55, 106496
    s_nop 0
    buffer_load_dwordx4 v3, s[20:23], s44 offen  lds
    s_mul_i32 s51, s48, 136
    s_add_u32 s51, s51, s38
    s_lshr_b32 s4, s47, 5
    s_add_u32 s52, s4, s51
    s_lshl_b32 s52, s52, 10
    s_add_u32 s52, s52, 7864320
    s_lshr_b32 s4, s46, 5
    s_add_u32 s51, s51, s4
    ds_read_b128 v[236:239], v71 offset:0
    ds_read_b64_tr_b16 v[24:25], v72 offset:12288
    ds_read_b64_tr_b16 v[26:27], v72 offset:13312
    ds_read_b64_tr_b16 v[28:29], v73 offset:12288
    ds_read_b64_tr_b16 v[30:31], v73 offset:13312
    s_setprio 1
    s_waitcnt lgkmcnt(7)
    v_mfma_f32_32x32x16_bf16 v[32:47], v[16:19], v[232:235], v[32:47]
    s_add_u32 m0, s45, 131072
    s_nop 0
    buffer_load_dwordx4 v255, s[76:79], s0 offen lds
    s_add_u32 m0, s45, 132096
    s_add_u32 s4, s0, s1
    buffer_load_dwordx4 v255, s[76:79], s4 offen lds
    s_waitcnt lgkmcnt(5)
    v_mfma_f32_32x32x16_bf16 v[48:63], v[20:23], v[232:235], v[48:63]
    s_waitcnt lgkmcnt(0)
    s_waitcnt vmcnt(6)
    s_barrier
    v_mfma_f32_32x32x16_bf16 v[32:47], v[24:27], v[236:239], v[32:47]
    ds_read_b128 v[240:243], v68 offset:16384
    ds_read_b64_tr_b16 v[16:17], v72 offset:16384
    ds_read_b64_tr_b16 v[18:19], v72 offset:17408
    ds_read_b64_tr_b16 v[20:21], v73 offset:16384
    ds_read_b64_tr_b16 v[22:23], v73 offset:17408
    v_mfma_f32_32x32x16_bf16 v[48:63], v[28:31], v[236:239], v[48:63]
    s_setprio 0
    s_add_u32 m0, s55, 49152
    s_add_u32 s44, s44, 196608
    s_cmp_eq_u32 s44, 1966080
    s_cselect_b32 s44, 0, s44
    buffer_load_dwordx4 v2, s[16:19], s44 offen  lds
    buffer_load_dwordx2 v[94:95], v11, s[24:27], 0 offen sc1
    s_cmp_ge_u32 s36, 4
    s_cbranch_scc1 F_ifw17
    v_cmp_gt_u32 vcc, 160, v12
    s_nop 1
    v_cndmask_b32 v13, v14, v13, vcc
    v_mov_b32 v14, 1073741824
    v_cmp_gt_u32 vcc, 224, v12
    s_nop 1
    v_cndmask_b32 v12, v14, v13, vcc
F_ifw17:
    s_cmp_lt_u32 s36, 4
    s_cbranch_scc1 F_ifw18
    s_mul_i32 s4, s40, 384
    s_add_u32 s4, s4, 19586560
    v_add_u32 v13, s4, v13
    v_mov_b32 v14, 1073741824
    v_cmp_gt_u32 vcc, 240, v12
    s_nop 1
    v_cndmask_b32 v12, v14, v13, vcc
F_ifw18:
    s_setprio 1
    s_waitcnt lgkmcnt(2)
    v_mfma_f32_32x32x16_bf16 v[32:47], v[16:19], v[240:243], v[32:47]
    s_branch F_pg2k
.p2align 12
F_pg2:
    s_setpc_b64 s[6:7]
F_pg2k:
    ds_read_b128 v[244:247], v69 offset:16384
    ds_read_b64_tr_b16 v[24:25], v72 offset:20480
    ds_read_b64_tr_b16 v[26:27], v72 offset:21504
    ds_read_b64_tr_b16 v[28:29], v73 offset:20480
    ds_read_b64_tr_b16 v[30:31], v73 offset:21504
    s_waitcnt lgkmcnt(5)
    v_mfma_f32_32x32x16_bf16 v[48:63], v[20:23], v[240:243], v[48:63]
    s_setprio 0
    s_add_u32 m0, s55, 114688
    s_nop 0
    buffer_load_dwordx4 v3, s[20:23], s44 offen  lds
    s_add_u32 s51, s51, s38
    s_lshl_b32 s51, s51, 10
    s_add_u32 s51, s51, 7864320
    s_and_b32 s56, s2, 7
    s_lshl_b32 s56, s56, 2
    s_bfe_u32 s4, s2, 0x20003
    s_add_u32 s56, s56, s4
    s_lshr_b32 s57, s2, 5
    s_and_b32 s60, s56, 1
    s_setprio 1
    s_waitcnt lgkmcnt(2)
    v_mfma_f32_32x32x16_bf16 v[32:47], v[24:27], v[244:247], v[32:47]
    ds_read_b128 v[248:251], v70 offset:16384
    ds_read_b64_tr_b16 v[16:17], v72 offset:24576
    ds_read_b64_tr_b16 v[18:19], v72 offset:25600
    ds_read_b64_tr_b16 v[20:21], v73 offset:24576
    ds_read_b64_tr_b16 v[22:23], v73 offset:25600
    s_waitcnt lgkmcnt(5)
    v_mfma_f32_32x32x16_bf16 v[48:63], v[28:31], v[244:247], v[48:63]
    s_setprio 0
    s_add_u32 m0, s55, 57344
    s_add_u32 s44, s44, 196608
    s_cmp_eq_u32 s44, 1966080
    s_cselect_b32 s44, 0, s44
    buffer_load_dwordx4 v2, s[16:19], s44 offen  lds
    s_lshr_b32 s4, s56, 1
    s_mul_i32 s4, s4, 5
    s_add_u32 s59, s4, 2
    s_mul_i32 s58, s60, 3
    s_add_u32 s58, s58, s4
    ds_read_b128 v[252:255], v71 offset:16384
    ds_read_b64_tr_b16 v[24:25], v72 offset:28672
    ds_read_b64_tr_b16 v[26:27], v72 offset:29696
    ds_read_b64_tr_b16 v[28:29], v73 offset:28672
    ds_read_b64_tr_b16 v[30:31], v73 offset:29696
    s_setprio 1
    s_waitcnt lgkmcnt(7)
    v_mfma_f32_32x32x16_bf16 v[32:47], v[16:19], v[248:251], v[32:47]
    s_add_u32 m0, s55, 122880
    s_nop 0
    buffer_load_dwordx4 v3, s[20:23], s44 offen  lds
    s_sub_u32 s61, s59, s58
    s_lshl_b32 s61, s61, 15
    s_waitcnt lgkmcnt(5)
    v_mfma_f32_32x32x16_bf16 v[48:63], v[20:23], v[248:251], v[48:63]
    s_waitcnt lgkmcnt(0)
    s_waitcnt vmcnt(9)
    s_barrier
    v_mfma_f32_32x32x16_bf16 v[32:47], v[24:27], v[252:255], v[32:47]
    ds_read_b64_tr_b16 v[16:17], v4 offset:32768
    ds_read_b64_tr_b16 v[18:19], v4 offset:33280
    ds_read_b64_tr_b16 v[20:21], v5 offset:32768
    ds_read_b64_tr_b16 v[22:23], v5 offset:33280
    v_mfma_f32_32x32x16_bf16 v[48:63], v[28:31], v[252:255], v[48:63]
    s_setprio 0
    s_add_u32 m0, s55, 0
    s_add_u32 s44, s44, 196608
    s_cmp_eq_u32 s44, 1966080
    s_cselect_b32 s44, 0, s44
    buffer_load_dwordx4 v2, s[16:19], s44 offen  lds
    s_add_u32 s4, s32, 1
    s_waitcnt vmcnt(4)
    v_xor_b32 v95, s33, v95
    v_subrev_u32 v94, s4, v94
    v_lshrrev_b32 v94, 3, v94
    v_or_b32 v95, v95, v94
    v_cmp_ne_u32 vcc, 0, v95
    s_nop 4
    s_cbranch_vccnz F_spin8
F_ok7:
    s_setprio 1
    s_waitcnt lgkmcnt(2)
    v_mfma_f32_32x32x16_bf16 v[64:79], v[16:19], v[96:99], 0
    ds_read_b64_tr_b16 v[24:25], v4 offset:34816
    ds_read_b64_tr_b16 v[26:27], v4 offset:35328
    ds_read_b64_tr_b16 v[28:29], v5 offset:34816
    ds_read_b64_tr_b16 v[30:31], v5 offset:35328
    s_waitcnt lgkmcnt(4)
    v_mfma_f32_32x32x16_bf16 v[80:95], v[20:23], v[96:99], 0
    s_setprio 0
    s_add_u32 m0, s55, 65536
    s_nop 0
    buffer_load_dwordx4 v3, s[20:23], s44 offen  lds
    s_mov_b32 s69, 0
    s_add_u32 s62, s58, 80
    s_lshl_b32 s62, s62, 15
    s_mul_i32 s4, s38, 12288
    s_add_u32 s62, s62, s4
    s_add_u32 s62, s62, s55
    s_mul_i32 s63, s56, 81920
    s_mul_i32 s4, s38, 40960
    s_add_u32 s63, s63, s4
    s_setprio 1
    s_waitcnt lgkmcnt(2)
    v_mfma_f32_32x32x16_bf16 v[64:79], v[24:27], v[100:103], v[64:79]
    ds_read_b64_tr_b16 v[16:17], v4 offset:36864
    ds_read_b64_tr_b16 v[18:19], v4 offset:37376
    ds_read_b64_tr_b16 v[20:21], v5 offset:36864
    ds_read_b64_tr_b16 v[22:23], v5 offset:37376
    s_waitcnt lgkmcnt(4)
    v_mfma_f32_32x32x16_bf16 v[80:95], v[28:31], v[100:103], v[80:95]
    s_setprio 0
    s_add_u32 m0, s55, 8192
    s_add_u32 s44, s44, 196608
    s_cmp_eq_u32 s44, 1966080
    s_cselect_b32 s44, 0, s44
    buffer_load_dwordx4 v2, s[16:19], s44 offen  lds
    s_mul_i32 s4, s37, 2560
    s_add_u32 s63, s63, s4
    s_add_u32 s63, s63, 5242880
    s_mov_b32 s67, 0
    ds_read_b64_tr_b16 v[24:25], v4 offset:38912
    ds_read_b64_tr_b16 v[26:27], v4 offset:39424
    ds_read_b64_tr_b16 v[28:29], v5 offset:38912
    ds_read_b64_tr_b16 v[30:31], v5 offset:39424
    s_setprio 1
    s_waitcnt lgkmcnt(6)
    v_mfma_f32_32x32x16_bf16 v[64:79], v[16:19], v[104:107], v[64:79]
    s_add_u32 m0, s55, 73728
    s_nop 0
    buffer_load_dwordx4 v3, s[20:23], s44 offen  lds
    s_waitcnt lgkmcnt(4)
    v_mfma_f32_32x32x16_bf16 v[80:95], v[20:23], v[104:107], v[80:95]
    s_waitcnt lgkmcnt(0)
    s_waitcnt vmcnt(11)
    s_barrier
    v_mfma_f32_32x32x16_bf16 v[64:79], v[24:27], v[108:111], v[64:79]
    ds_read_b64_tr_b16 v[16:17], v4 offset:40960
    ds_read_b64_tr_b16 v[18:19], v4 offset:41472
    ds_read_b64_tr_b16 v[20:21], v5 offset:40960
    ds_read_b64_tr_b16 v[22:23], v5 offset:41472
    v_mfma_f32_32x32x16_bf16 v[80:95], v[28:31], v[108:111], v[80:95]
    s_setprio 0
    s_add_u32 m0, s55, 16384
    s_add_u32 s44, s44, 196608
    s_cmp_eq_u32 s44, 1966080
    s_cselect_b32 s44, 0, s44
    buffer_load_dwordx4 v2, s[16:19], s44 offen  lds
    s_add_u32 m0, s55, 147456
    s_nop 0
    buffer_load_dwordx4 v12, s[24:27], 0 offen sc1 lds
    s_lshl_b32 s5, s38, 16
    s_add_u32 s5, s5, 24576
    s_mul_i32 s4, s37, 3072
    s_add_u32 s64, s5, s4
    s_setprio 1
    s_waitcnt lgkmcnt(2)
    v_mfma_f32_32x32x16_bf16 v[64:79], v[16:19], v[112:115], v[64:79]
    ds_read_b64_tr_b16 v[24:25], v4 offset:43008
    ds_read_b64_tr_b16 v[26:27], v4 offset:43520
    ds_read_b64_tr_b16 v[28:29], v5 offset:43008
    ds_read_b64_tr_b16 v[30:31], v5 offset:43520
    s_waitcnt lgkmcnt(4)
    v_mfma_f32_32x32x16_bf16 v[80:95], v[20:23], v[112:115], v[80:95]
    s_setprio 0
    s_add_u32 m0, s55, 81920
    s_nop 0
    buffer_load_dwordx4 v3, s[20:23], s44 offen  lds
    s_lshl_b32 s5, s38, 16
    s_mul_i32 s4, s37, 2560
    s_add_u32 s65, s5, s4
    s_add_u32 s65, s65, 36864
    s_mov_b32 s12, 0x000fffff
    s_mov_b32 s13, 0x000fffff
    s_setprio 1
    s_waitcnt lgkmcnt(2)
    v_mfma_f32_32x32x16_bf16 v[64:79], v[24:27], v[116:119], v[64:79]
    ds_read_b64_tr_b16 v[16:17], v4 offset:45056
    ds_read_b64_tr_b16 v[18:19], v4 offset:45568
    ds_read_b64_tr_b16 v[20:21], v5 offset:45056
    ds_read_b64_tr_b16 v[22:23], v5 offset:45568
    s_waitcnt lgkmcnt(4)
    v_mfma_f32_32x32x16_bf16 v[80:95], v[28:31], v[116:119], v[80:95]
    s_setprio 0
    s_add_u32 m0, s55, 24576
    s_add_u32 s44, s44, 196608
    s_cmp_eq_u32 s44, 1966080
    s_cselect_b32 s44, 0, s44
    buffer_load_dwordx4 v2, s[16:19], s44 offen  lds
    s_lshl_b32 s4, s38, 8
    s_add_u32 s4, s4, 147456
    v_lshl_add_u32 v9, v0, 2, s4
    s_lshl_b32 s4, s37, 8
    s_add_u32 s4, s4, 150016
    v_and_b32 v6, 31, v0
    v_lshl_add_u32 v6, v6, 3, s4
    ds_read_b64_tr_b16 v[24:25], v4 offset:47104
    ds_read_b64_tr_b16 v[26:27], v4 offset:47616
    ds_read_b64_tr_b16 v[28:29], v5 offset:47104
    ds_read_b64_tr_b16 v[30:31], v5 offset:47616
    s_setprio 1
    s_waitcnt lgkmcnt(6)
    v_mfma_f32_32x32x16_bf16 v[64:79], v[16:19], v[120:123], v[64:79]
    s_add_u32 m0, s55, 90112
    s_nop 0
    buffer_load_dwordx4 v3, s[20:23], s44 offen  lds
    s_mov_b32 s14, -1
    s_mov_b32 s15, 0
    s_waitcnt lgkmcnt(4)
    v_mfma_f32_32x32x16_bf16 v[80:95], v[20:23], v[120:123], v[80:95]
    s_waitcnt lgkmcnt(0)
    s_waitcnt vmcnt(11)
    s_waitcnt vmcnt(3)
    s_barrier
    v_mfma_f32_32x32x16_bf16 v[64:79], v[24:27], v[124:127], v[64:79]
    ds_read_b64_tr_b16 v[16:17], v4 offset:49152
    ds_read_b64_tr_b16 v[18:19], v4 offset:49664
    ds_read_b64_tr_b16 v[20:21], v5 offset:49152
    ds_read_b64_tr_b16 v[22:23], v5 offset:49664
    v_mfma_f32_32x32x16_bf16 v[80:95], v[28:31], v[124:127], v[80:95]
    s_setprio 0
    s_add_u32 m0, s55, 32768
    s_add_u32 s44, s44, 196608
    s_cmp_eq_u32 s44, 1966080
    s_cselect_b32 s44, 0, s44
    buffer_load_dwordx4 v2, s[16:19], s44 offen  lds
    ds_read2st64_b32 v[12:13], v9 offset0:0 offset1:2
    ds_read2st64_b32 v[14:15], v9 offset0:4 offset1:6
    ds_read_b32 v8, v9 offset:2048
    ds_read_b64 v[6:7], v6
    s_setprio 1
    s_waitcnt lgkmcnt(6)
    v_mfma_f32_32x32x16_bf16 v[64:79], v[16:19], v[128:131], v[64:79]
    ds_read_b64_tr_b16 v[24:25], v4 offset:51200
    ds_read_b64_tr_b16 v[26:27], v4 offset:51712
    ds_read_b64_tr_b16 v[28:29], v5 offset:51200
    ds_read_b64_tr_b16 v[30:31], v5 offset:51712
    s_waitcnt lgkmcnt(8)
    v_mfma_f32_32x32x16_bf16 v[80:95], v[20:23], v[128:131], v[80:95]
    s_setprio 0
    s_add_u32 m0, s55, 98304
    s_nop 0
    buffer_load_dwordx4 v3, s[20:23], s44 offen  lds
    s_waitcnt lgkmcnt(7)
    v_add_f32 v12, v12, v13
    s_waitcnt lgkmcnt(6)
    v_add_f32 v14, v14, v15
    s_waitcnt lgkmcnt(5)
    v_add_f32 v12, v12, v8
    v_add_f32 v12, v12, v14
    v_cvt_pk_bf16_f32 v13, v12, v12
    v_lshlrev_b32 v13, 16, v13
    v_sub_f32 v13, v12, v13
    v_cvt_pk_bf16_f32 v14, v12, v13
    v_and_b32 v12, 0xffff0000, v14
    v_sub_f32 v13, v13, v12
    v_cvt_pk_bf16_f32 v15, v13, 0
    s_waitcnt lgkmcnt(4)
    v_cndmask_b32 v8, 0, v7, s[14:15]
    v_cndmask_b32 v12, v7, 0, s[14:15]
    v_and_b32 v9, 0xffff, v8
    s_setprio 1
    s_waitcnt lgkmcnt(2)
    v_mfma_f32_32x32x16_bf16 v[64:79], v[24:27], v[132:135], v[64:79]
    ds_read_b64_tr_b16 v[16:17], v4 offset:53248
    ds_read_b64_tr_b16 v[18:19], v4 offset:53760
    ds_read_b64_tr_b16 v[20:21], v5 offset:53248
    ds_read_b64_tr_b16 v[22:23], v5 offset:53760
    s_waitcnt lgkmcnt(4)
    v_mfma_f32_32x32x16_bf16 v[80:95], v[28:31], v[132:135], v[80:95]
    s_setprio 0
    s_add_u32 m0, s55, 40960
    s_add_u32 s44, s44, 196608
    s_cmp_eq_u32 s44, 1966080
    s_cselect_b32 s44, 0, s44
    buffer_load_dwordx4 v2, s[16:19], s44 offen  lds
    v_and_b32 v13, 0xffff, v12
    v_mul_f32 v7, s49, v6
    v_mfma_f32_32x32x8_bf16 v[32:47], v[14:15], v[8:9], v[32:47]
    v_mfma_f32_32x32x8_bf16 v[48:63], v[14:15], v[12:13], v[48:63]
    s_nop 10
    v_mul_f32 v32, v7, v32
    v_mul_f32 v33, v7, v33
    v_mul_f32 v34, v7, v34
    ds_read_b64_tr_b16 v[24:25], v4 offset:55296
    ds_read_b64_tr_b16 v[26:27], v4 offset:55808
    ds_read_b64_tr_b16 v[28:29], v5 offset:55296
    ds_read_b64_tr_b16 v[30:31], v5 offset:55808
    s_setprio 1
    s_waitcnt lgkmcnt(6)
    v_mfma_f32_32x32x16_bf16 v[64:79], v[16:19], v[136:139], v[64:79]
    s_add_u32 m0, s55, 106496
    s_nop 0
    buffer_load_dwordx4 v3, s[20:23], s44 offen  lds
    v_mul_f32 v35, v7, v35
    v_mul_f32 v36, v7, v36
    v_mul_f32 v37, v7, v37
    v_mul_f32 v38, v7, v38
    v_mul_f32 v39, v7, v39
    s_waitcnt lgkmcnt(4)
    v_mfma_f32_32x32x16_bf16 v[80:95], v[20:23], v[136:139], v[80:95]
    s_waitcnt lgkmcnt(0)
    s_waitcnt vmcnt(13)
    s_barrier
    v_mfma_f32_32x32x16_bf16 v[64:79], v[24:27], v[140:143], v[64:79]
    ds_read_b64_tr_b16 v[16:17], v4 offset:57344
    ds_read_b64_tr_b16 v[18:19], v4 offset:57856
    ds_read_b64_tr_b16 v[20:21], v5 offset:57344
    ds_read_b64_tr_b16 v[22:23], v5 offset:57856
    v_mfma_f32_32x32x16_bf16 v[80:95], v[28:31], v[140:143], v[80:95]
    s_setprio 0
    v_cvt_pk_bf16_f32 v32, v32, v33
    v_cvt_pk_bf16_f32 v33, v34, v35
    v_cvt_pk_bf16_f32 v34, v36, v37
    v_cvt_pk_bf16_f32 v35, v38, v39
    s_nop 0
    v_permlane32_swap_b32 v32, v34
    v_permlane32_swap_b32 v33, v35
    s_add_u32 s50, s75, 0
    buffer_store_dwordx4 v[32:35], v10, s[24:27], s50 offen sc0 sc1
    v_mul_f32 v40, v7, v40
    v_mul_f32 v41, v7, v41
    v_mul_f32 v42, v7, v42
    v_mul_f32 v43, v7, v43
    v_mul_f32 v44, v7, v44
    v_mul_f32 v45, v7, v45
    v_mul_f32 v46, v7, v46
    v_mul_f32 v47, v7, v47
    s_setprio 1
    s_waitcnt lgkmcnt(2)
    v_mfma_f32_32x32x16_bf16 v[64:79], v[16:19], v[144:147], v[64:79]
    ds_read_b64_tr_b16 v[24:25], v4 offset:59392
    ds_read_b64_tr_b16 v[26:27], v4 offset:59904
    ds_read_b64_tr_b16 v[28:29], v5 offset:59392
    ds_read_b64_tr_b16 v[30:31], v5 offset:59904
    s_waitcnt lgkmcnt(4)
    v_mfma_f32_32x32x16_bf16 v[80:95], v[20:23], v[144:147], v[80:95]
    s_setprio 0
    v_cvt_pk_bf16_f32 v40, v40, v41
    v_cvt_pk_bf16_f32 v41, v42, v43
    v_cvt_pk_bf16_f32 v42, v44, v45
    v_cvt_pk_bf16_f32 v43, v46, v47
    s_nop 0
    v_permlane32_swap_b32 v40, v42
    v_permlane32_swap_b32 v41, v43
    s_add_u32 s50, s75, 65536
    buffer_store_dwordx4 v[40:43], v10, s[24:27], s50 offen sc0 sc1
    v_mul_f32 v48, v7, v48
    v_mul_f32 v49, v7, v49
    v_mul_f32 v50, v7, v50
    v_mul_f32 v51, v7, v51
    v_mul_f32 v52, v7, v52
    v_mul_f32 v53, v7, v53
    v_mul_f32 v54, v7, v54
    v_mul_f32 v55, v7, v55
    v_cvt_pk_bf16_f32 v48, v48, v49
    s_setprio 1
    s_waitcnt lgkmcnt(2)
    v_mfma_f32_32x32x16_bf16 v[64:79], v[24:27], v[148:151], v[64:79]
    ds_read_b64_tr_b16 v[16:17], v4 offset:61440
    ds_read_b64_tr_b16 v[18:19], v4 offset:61952
    ds_read_b64_tr_b16 v[20:21], v5 offset:61440
    ds_read_b64_tr_b16 v[22:23], v5 offset:61952
    s_waitcnt lgkmcnt(4)
    v_mfma_f32_32x32x16_bf16 v[80:95], v[28:31], v[148:151], v[80:95]
    s_setprio 0
    v_cvt_pk_bf16_f32 v49, v50, v51
    v_cvt_pk_bf16_f32 v50, v52, v53
    v_cvt_pk_bf16_f32 v51, v54, v55
    s_nop 0
    v_permlane32_swap_b32 v48, v50
    v_permlane32_swap_b32 v49, v51
    s_add_u32 s50, s75, 131072
    buffer_store_dwordx4 v[48:51], v10, s[24:27], s50 offen sc0 sc1
    v_mul_f32 v56, v7, v56
    v_mul_f32 v57, v7, v57
    v_mul_f32 v58, v7, v58
    v_mul_f32 v59, v7, v59
    v_mul_f32 v60, v7, v60
    v_mul_f32 v61, v7, v61
    v_mul_f32 v62, v7, v62
    v_mul_f32 v63, v7, v63
    v_cvt_pk_bf16_f32 v56, v56, v57
    ds_read_b64_tr_b16 v[24:25], v4 offset:63488
    ds_read_b64_tr_b16 v[26:27], v4 offset:64000
    ds_read_b64_tr_b16 v[28:29], v5 offset:63488
    ds_read_b64_tr_b16 v[30:31], v5 offset:64000
    s_setprio 1
    s_waitcnt lgkmcnt(6)
    v_mfma_f32_32x32x16_bf16 v[64:79], v[16:19], v[152:155], v[64:79]
    v_cvt_pk_bf16_f32 v57, v58, v59
    v_cvt_pk_bf16_f32 v58, v60, v61
    v_cvt_pk_bf16_f32 v59, v62, v63
    s_nop 0
    v_permlane32_swap_b32 v56, v58
    v_permlane32_swap_b32 v57, v59
    s_add_u32 s50, s75, 196608
    buffer_store_dwordx4 v[56:59], v10, s[24:27], s50 offen sc0 sc1
    s_waitcnt lgkmcnt(4)
    v_mfma_f32_32x32x16_bf16 v[80:95], v[20:23], v[152:155], v[80:95]
    s_waitcnt lgkmcnt(0)
    s_waitcnt vmcnt(15)
    s_barrier
    s_branch F_join
F_v:
    s_add_u32 m0, s45, 81920
    s_mul_i32 s43, s42, 1920
    buffer_load_dwordx4 v66, s[12:15], s43 offen  lds
    s_add_u32 m0, s45, 82944
    s_nop 0
    buffer_load_dwordx4 v67, s[12:15], s43 offen  lds
    s_waitcnt lgkmcnt(0)
    s_waitcnt vmcnt(4)
    s_barrier
    ds_read_b128 v[96:99], v68 offset:0
    ds_read_b64_tr_b16 v[16:17], v72 offset:0
    ds_read_b64_tr_b16 v[18:19], v72 offset:1024
    ds_read_b64_tr_b16 v[20:21], v73 offset:0
    ds_read_b64_tr_b16 v[22:23], v73 offset:1024
    s_setprio 1
    s_waitcnt lgkmcnt(2)
    v_mfma_f32_32x32x16_bf16 v[32:47], v[96:99], v[16:19], 0
    ds_read_b128 v[100:103], v69 offset:0
    ds_read_b64_tr_b16 v[24:25], v72 offset:4096
    ds_read_b64_tr_b16 v[26:27], v72 offset:5120
    ds_read_b64_tr_b16 v[28:29], v73 offset:4096
    ds_read_b64_tr_b16 v[30:31], v73 offset:5120
    s_waitcnt lgkmcnt(5)
    v_mfma_f32_32x32x16_bf16 v[48:63], v[96:99], v[20:23], 0
    s_setprio 0
    s_and_b32 s48, s2, 1
    s_lshl_b32 s48, s48, 5
    s_add_u32 s48, s48, s46
    s_mul_i32 s47, s48, 205
    s_lshr_b32 s47, s47, 10
    s_mul_i32 s35, s47, 5
    s_sub_u32 s35, s48, s35
    s_lshl_b32 s4, s35, 3
    s_add_u32 s4, s4, s36
    s_lshl_b32 s4, s4, 4
    v_lshrrev_b32 v93, 3, v0
    v_add_u32 v93, s4, v93
    v_and_b32 v94, 0x70, v1
    v_mul_u32_u24 v92, 3840, v93
    v_add_u32 v92, v92, v94
    v_mul_u32_u24 v95, 3072, v93
    v_add_u32 v95, v95, v94
    s_bfe_u32 s4, s2, 0x20001
    s_lshl_b32 s4, s4, 3
    s_add_u32 s4, s4, s47
    s_lshl_b32 s53, s4, 6
    s_add_u32 m0, s45, 32768
    s_add_u32 s42, s42, 128
    s_cmp_eq_u32 s42, 1280
    s_cselect_b32 s42, 0, s42
    buffer_load_dwordx4 v64, s[8:11], s42 offen  lds
    s_add_u32 m0, s45, 33792
    s_nop 0
    buffer_load_dwordx4 v65, s[8:11], s42 offen  lds
    s_setprio 1
    s_waitcnt lgkmcnt(2)
    v_mfma_f32_32x32x16_bf16 v[32:47], v[100:103], v[24:27], v[32:47]
    ds_read_b128 v[104:107], v70 offset:0
    ds_read_b64_tr_b16 v[16:17], v72 offset:8192
    ds_read_b64_tr_b16 v[18:19], v72 offset:9216
    ds_read_b64_tr_b16 v[20:21], v73 offset:8192
    ds_read_b64_tr_b16 v[22:23], v73 offset:9216
    s_waitcnt lgkmcnt(5)
    v_mfma_f32_32x32x16_bf16 v[48:63], v[100:103], v[28:31], v[48:63]
    s_setprio 0
    s_cmp_lt_u32 s48, 40
    s_cselect_b32 s4, s53, 4096
    s_cmp_lt_u32 s4, 1920
    s_cselect_b32 s53, s53, 268435456
    s_lshl_b32 s34, s53, 1
    s_mul_i32 s35, s35, 19968
    s_and_b32 s4, s36, 1
    s_lshl_b32 s4, s4, 7
    s_add_u32 s35, s35, s4
    s_add_u32 s35, s35, 19578880
    s_lshl_b32 s53, s53, 2
    s_add_u32 s53, s53, s35
    s_cmp_ge_u32 s47, 6
    s_cselect_b32 s28, s66, s64
    s_cselect_b32 s29, s67, s65
    s_cselect_b32 s4, 6144, 0
    s_add_u32 s35, s35, s4
    s_cmp_ge_u32 s47, 6
    s_cselect_b32 s4, 6, 0
    s_sub_u32 s47, s47, s4
    s_and_b32 s29, s29, 0xffff
    s_mov_b32 s30, 1966080
    s_mov_b32 s31, 0x00020000
    s_lshr_b32 s4, s40, 2
    s_mul_i32 s4, s4, 6
    s_add_u32 s4, s4, s47
    s_lshl_b32 s47, s4, 7
    s_add_u32 m0, s45, 98304
    s_mul_i32 s43, s42, 1920
    buffer_load_dwordx4 v66, s[12:15], s43 offen  lds
    s_add_u32 m0, s45, 99328
    s_nop 0
    buffer_load_dwordx4 v67, s[12:15], s43 offen  lds
    ds_read_b128 v[108:111], v71 offset:0
    ds_read_b64_tr_b16 v[24:25], v72 offset:12288
    ds_read_b64_tr_b16 v[26:27], v72 offset:13312
    ds_read_b64_tr_b16 v[28:29], v73 offset:12288
    ds_read_b64_tr_b16 v[30:31], v73 offset:13312
    s_setprio 1
    s_waitcnt lgkmcnt(7)
    v_mfma_f32_32x32x16_bf16 v[32:47], v[104:107], v[16:19], v[32:47]
    s_cmp_lt_u32 s48, 60
    s_cselect_b32 s49, s47, 536870912
    s_mul_i32 s50, s54, 1280
    buffer_load_dwordx4 v[74:77], v79, s[8:11], s50 offen
    buffer_load_dword v78, v79, s[8:11], s50 offen offset:16
    s_add_u32 m0, s45, 49152
    s_add_u32 s42, s42, 128
    s_cmp_eq_u32 s42, 1280
    s_cselect_b32 s42, 0, s42
    buffer_load_dwordx4 v64, s[8:11], s42 offen  lds
    s_waitcnt lgkmcnt(5)
    v_mfma_f32_32x32x16_bf16 v[48:63], v[104:107], v[20:23], v[48:63]
    s_cmp_ge_u32 s36, 4
    s_cbranch_scc1 F_cv0r
    s_cmp_eq_u32 s36, 1
    s_cbranch_scc1 F_cv0w1
    s_cmp_eq_u32 s36, 2
    s_cbranch_scc1 F_cv0w2
    s_cmp_eq_u32 s36, 3
    s_cbranch_scc1 F_cv0w3
    s_call_b64 s[6:7], F_pg3
    s_branch F_cv0r
F_cv0w1:
    s_call_b64 s[6:7], F_pg4
    s_branch F_cv0r
F_cv0w2:
    s_call_b64 s[6:7], F_pg5
    s_branch F_cv0r
F_cv0w3:
    s_call_b64 s[6:7], F_pg6
F_cv0r:
    s_waitcnt lgkmcnt(0)
    s_waitcnt vmcnt(7)
    s_barrier
    v_mfma_f32_32x32x16_bf16 v[32:47], v[108:111], v[24:27], v[32:47]
    ds_read_b128 v[112:115], v68 offset:16384
    ds_read_b64_tr_b16 v[16:17], v72 offset:16384
    ds_read_b64_tr_b16 v[18:19], v72 offset:17408
    ds_read_b64_tr_b16 v[20:21], v73 offset:16384
    ds_read_b64_tr_b16 v[22:23], v73 offset:17408
    v_mfma_f32_32x32x16_bf16 v[48:63], v[108:111], v[28:31], v[48:63]
    s_setprio 0
    s_lshl_b32 s54, s54, 3
    s_add_u32 s54, s54, 19562496
    s_cmp_lt_u32 s48, 60
    s_cselect_b32 s4, s47, 536870912
    s_lshl_b32 s4, s4, 1
    s_add_u32 s4, s4, 7680
    s_add_u32 s35, s35, s4
    s_cmp_lt_u32 s36, 6
    s_cselect_b32 s53, s53, s35
    v_lshrrev_b32 v93, 5, v0
    v_bfe_u32 v94, v0, 2, 2
    v_lshl_add_u32 v93, v93, 3, v94
    s_add_u32 m0, s45, 50176
    s_nop 0
    buffer_load_dwordx4 v65, s[8:11], s42 offen  lds
    s_add_u32 m0, s45, 147456
    s_nop 0
    buffer_load_dwordx4 v95, s[28:31], s49 offen lds
    s_setprio 1
    s_waitcnt lgkmcnt(2)
    v_mfma_f32_32x32x16_bf16 v[32:47], v[112:115], v[16:19], v[32:47]
    ds_read_b128 v[116:119], v69 offset:16384
    ds_read_b64_tr_b16 v[24:25], v72 offset:20480
    ds_read_b64_tr_b16 v[26:27], v72 offset:21504
    ds_read_b64_tr_b16 v[28:29], v73 offset:20480
    ds_read_b64_tr_b16 v[30:31], v73 offset:21504
    s_waitcnt lgkmcnt(5)
    v_mfma_f32_32x32x16_bf16 v[48:63], v[112:115], v[20:23], v[48:63]
    s_setprio 0
    v_lshlrev_b32 v93, 7, v93
    v_bfe_u32 v94, v0, 4, 1
    v_lshl_add_u32 v93, v94, 5, v93
    v_and_b32 v94, 3, v0
    v_lshl_add_u32 v93, v94, 3, v93
    s_and_b32 s4, s36, 1
    s_lshl_b32 s4, s4, 6
    s_and_b32 s5, s36, 2
    s_lshl_b32 s5, s5, 13
    s_add_u32 s4, s4, s5
    s_add_u32 s4, s4, 131072
    v_add_u32 v94, s4, v93
    s_add_u32 m0, s45, 114688
    s_mul_i32 s43, s42, 1920
    buffer_load_dwordx4 v66, s[12:15], s43 offen  lds
    s_add_u32 m0, s45, 148480
    s_add_u32 s49, s49, 24576
    buffer_load_dwordx4 v95, s[28:31], s49 offen lds
    s_setprio 1
    s_waitcnt lgkmcnt(2)
    v_mfma_f32_32x32x16_bf16 v[32:47], v[116:119], v[24:27], v[32:47]
    ds_read_b128 v[120:123], v70 offset:16384
    ds_read_b64_tr_b16 v[16:17], v72 offset:24576
    ds_read_b64_tr_b16 v[18:19], v72 offset:25600
    ds_read_b64_tr_b16 v[20:21], v73 offset:24576
    ds_read_b64_tr_b16 v[22:23], v73 offset:25600
    s_waitcnt lgkmcnt(5)
    v_mfma_f32_32x32x16_bf16 v[48:63], v[116:119], v[28:31], v[48:63]
    s_setprio 0
    s_mov_b32 s4, 0x00100001
    s_mov_b32 s5, s4
    v_mov_b32 v85, 0x3f803f80
    v_cndmask_b32 v84, 0, v85, s[4:5]
    v_mov_b32 v85, v84
    v_mov_b32 v86, v84
    v_mov_b32 v87, v84
    s_add_u32 m0, s45, 115712
    s_nop 0
    buffer_load_dwordx4 v67, s[12:15], s43 offen  lds
    s_add_u32 m0, s45, 131072
    s_nop 0
    buffer_load_dwordx4 v92, s[12:15], s34 offen lds
    ds_read_b128 v[124:127], v71 offset:16384
    ds_read_b64_tr_b16 v[24:25], v72 offset:28672
    ds_read_b64_tr_b16 v[26:27], v72 offset:29696
    ds_read_b64_tr_b16 v[28:29], v73 offset:28672
    ds_read_b64_tr_b16 v[30:31], v73 offset:29696
    s_setprio 1
    s_waitcnt lgkmcnt(7)
    v_mfma_f32_32x32x16_bf16 v[32:47], v[120:123], v[16:19], v[32:47]
    s_add_u32 m0, s45, 0
    s_add_u32 s42, s42, 128
    s_cmp_eq_u32 s42, 1280
    s_cselect_b32 s42, 0, s42
    buffer_load_dwordx4 v64, s[8:11], s42 offen  lds
    s_add_u32 m0, s45, 132096
    s_add_u32 s34, s34, 30720
    buffer_load_dwordx4 v92, s[12:15], s34 offen lds
    s_waitcnt lgkmcnt(5)
    v_mfma_f32_32x32x16_bf16 v[48:63], v[120:123], v[20:23], v[48:63]
    s_cmp_ge_u32 s36, 3
    s_cbranch_scc1 F_cv1r
    s_cmp_eq_u32 s36, 1
    s_cbranch_scc1 F_cv1w1
    s_cmp_eq_u32 s36, 2
    s_cbranch_scc1 F_cv1w2
    s_call_b64 s[6:7], F_pg7
    s_branch F_cv1r
F_cv1w1:
    s_call_b64 s[6:7], F_pg8
    s_branch F_cv1r
F_cv1w2:
    s_call_b64 s[6:7], F_ps
F_cv1r:
    s_waitcnt lgkmcnt(0)
    s_waitcnt vmcnt(11)
    s_barrier
    v_mfma_f32_32x32x16_bf16 v[32:47], v[124:127], v[24:27], v[32:47]
    ds_read_b128 v[128:131], v68 offset:32768
    ds_read_b64_tr_b16 v[16:17], v72 offset:32768
    ds_read_b64_tr_b16 v[18:19], v72 offset:33792
    ds_read_b64_tr_b16 v[20:21], v73 offset:32768
    ds_read_b64_tr_b16 v[22:23], v73 offset:33792
    v_mfma_f32_32x32x16_bf16 v[48:63], v[124:127], v[28:31], v[48:63]
    s_branch F_pg3k
.p2align 12
F_pg3:
    s_setpc_b64 s[6:7]
F_pg3k:
    s_setprio 0
    s_waitcnt vmcnt(10)
    v_lshlrev_b32 v81, 16, v74
    v_and_b32 v82, 0xffff0000, v74
    v_add_f32 v79, v81, v82
    v_mul_f32 v80, v81, v81
    v_fmac_f32 v80, v82, v82
    v_lshlrev_b32 v81, 16, v75
    v_and_b32 v82, 0xffff0000, v75
    v_add_f32 v79, v79, v81
    v_fmac_f32 v80, v81, v81
    v_add_f32 v79, v79, v82
    v_fmac_f32 v80, v82, v82
    v_lshlrev_b32 v81, 16, v76
    v_and_b32 v82, 0xffff0000, v76
    s_add_u32 m0, s45, 1024
    s_nop 0
    buffer_load_dwordx4 v65, s[8:11], s42 offen  lds
    s_setprio 1
    s_waitcnt lgkmcnt(2)
    v_mfma_f32_32x32x16_bf16 v[32:47], v[128:131], v[16:19], v[32:47]
    ds_read_b128 v[132:135], v69 offset:32768
    ds_read_b64_tr_b16 v[24:25], v72 offset:36864
    ds_read_b64_tr_b16 v[26:27], v72 offset:37888
    ds_read_b64_tr_b16 v[28:29], v73 offset:36864
    ds_read_b64_tr_b16 v[30:31], v73 offset:37888
    s_waitcnt lgkmcnt(5)
    v_mfma_f32_32x32x16_bf16 v[48:63], v[128:131], v[20:23], v[48:63]
    s_setprio 0
    v_add_f32 v79, v79, v81
    v_fmac_f32 v80, v81, v81
    v_add_f32 v79, v79, v82
    v_fmac_f32 v80, v82, v82
    v_lshlrev_b32 v81, 16, v77
    v_and_b32 v82, 0xffff0000, v77
    v_add_f32 v79, v79, v81
    v_fmac_f32 v80, v81, v81
    v_add_f32 v79, v79, v82
    v_fmac_f32 v80, v82, v82
    s_waitcnt vmcnt(10)
    v_lshlrev_b32 v81, 16, v78
    v_and_b32 v82, 0xffff0000, v78
    v_add_f32 v79, v79, v81
    s_add_u32 m0, s45, 65536
    s_mul_i32 s43, s42, 1920
    buffer_load_dwordx4 v66, s[12:15], s43 offen  lds
    s_setprio 1
    s_waitcnt lgkmcnt(2)
    v_mfma_f32_32x32x16_bf16 v[32:47], v[132:135], v[24:27], v[32:47]
    ds_read_b128 v[136:139], v70 offset:32768
    ds_read_b64_tr_b16 v[16:17], v72 offset:40960
    ds_read_b64_tr_b16 v[18:19], v72 offset:41984
    ds_read_b64_tr_b16 v[20:21], v73 offset:40960
    ds_read_b64_tr_b16 v[22:23], v73 offset:41984
    s_waitcnt lgkmcnt(5)
    v_mfma_f32_32x32x16_bf16 v[48:63], v[132:135], v[28:31], v[48:63]
    s_setprio 0
    v_mov_b32 v252, 0
    global_load_dwordx2 v[252:253], v252, s[72:73] sc1
    v_fmac_f32 v80, v81, v81
    v_add_f32 v79, v79, v82
    v_fmac_f32 v80, v82, v82
    s_nop 0
    v_add_f32_dpp v79, v79, v79 row_shr:1 row_mask:0xf bank_mask:0xf bound_ctrl:0
    v_add_f32_dpp v80, v80, v80 row_shr:1 row_mask:0xf bank_mask:0xf bound_ctrl:0
    s_nop 0
    v_add_f32_dpp v79, v79, v79 row_shr:2 row_mask:0xf bank_mask:0xf bound_ctrl:0
    v_add_f32_dpp v80, v80, v80 row_shr:2 row_mask:0xf bank_mask:0xf bound_ctrl:0
    s_nop 0
    v_add_f32_dpp v79, v79, v79 row_shr:4 row_mask:0xf bank_mask:0xf bound_ctrl:0
    v_add_f32_dpp v80, v80, v80 row_shr:4 row_mask:0xf bank_mask:0xf bound_ctrl:0
    s_add_u32 m0, s45, 66560
    s_nop 0
    buffer_load_dwordx4 v67, s[12:15], s43 offen  lds
    ds_read_b128 v[140:143], v71 offset:32768
    ds_read_b64_tr_b16 v[24:25], v72 offset:45056
    ds_read_b64_tr_b16 v[26:27], v72 offset:46080
    ds_read_b64_tr_b16 v[28:29], v73 offset:45056
    ds_read_b64_tr_b16 v[30:31], v73 offset:46080
    s_setprio 1
    s_waitcnt lgkmcnt(7)
    v_mfma_f32_32x32x16_bf16 v[32:47], v[136:139], v[16:19], v[32:47]
    v_add_f32_dpp v79, v79, v79 row_shr:8 row_mask:0xf bank_mask:0xf bound_ctrl:0
    v_add_f32_dpp v80, v80, v80 row_shr:8 row_mask:0xf bank_mask:0xf bound_ctrl:0
    s_add_u32 m0, s45, 16384
    s_add_u32 s42, s42, 128
    s_cmp_eq_u32 s42, 1280
    s_cselect_b32 s42, 0, s42
    buffer_load_dwordx4 v64, s[8:11], s42 offen  lds
    s_waitcnt lgkmcnt(5)
    v_mfma_f32_32x32x16_bf16 v[48:63], v[136:139], v[20:23], v[48:63]
    s_waitcnt lgkmcnt(0)
    s_waitcnt vmcnt(8)
    s_waitcnt vmcnt(5)
    s_barrier
    v_mfma_f32_32x32x16_bf16 v[32:47], v[140:143], v[24:27], v[32:47]
    ds_read_b128 v[144:147], v68 offset:49152
    ds_read_b64_tr_b16 v[16:17], v72 offset:49152
    ds_read_b64_tr_b16 v[18:19], v72 offset:50176
    ds_read_b64_tr_b16 v[20:21], v73 offset:49152
    ds_read_b64_tr_b16 v[22:23], v73 offset:50176
    v_mfma_f32_32x32x16_bf16 v[48:63], v[140:143], v[28:31], v[48:63]
    s_setprio 0
    s_cmp_lt_u32 s36, 4
    s_cbranch_scc1 F_ifw27
    ds_read_b64_tr_b16 v[236:237], v94 offset:0
    ds_read_b64_tr_b16 v[238:239], v94 offset:512
    ds_read_b64_tr_b16 v[240:241], v94 offset:2048
    ds_read_b64_tr_b16 v[242:243], v94 offset:2560
    ds_read_b64_tr_b16 v[244:245], v94 offset:4096
    ds_read_b64_tr_b16 v[246:247], v94 offset:4608
    ds_read_b64_tr_b16 v[248:249], v94 offset:6144
    ds_read_b64_tr_b16 v[250:251], v94 offset:6656
F_ifw27:
    v_add_f32_dpp v79, v79, v79 row_bcast:15 row_mask:0xa bank_mask:0xf
    v_add_f32_dpp v80, v80, v80 row_bcast:15 row_mask:0xa bank_mask:0xf
    s_nop 0
    v_add_f32_dpp v79, v79, v79 row_bcast:31 row_mask:0xc bank_mask:0xf
    v_add_f32_dpp v80, v80, v80 row_bcast:31 row_mask:0xc bank_mask:0xf
    s_add_u32 m0, s45, 17408
    s_nop 0
    buffer_load_dwordx4 v65, s[8:11], s42 offen  lds
    s_setprio 1
    s_waitcnt lgkmcnt(2)
    v_mfma_f32_32x32x16_bf16 v[32:47], v[144:147], v[16:19], v[32:47]
    ds_read_b128 v[148:151], v69 offset:49152
    ds_read_b64_tr_b16 v[24:25], v72 offset:53248
    ds_read_b64_tr_b16 v[26:27], v72 offset:54272
    ds_read_b64_tr_b16 v[28:29], v73 offset:53248
    ds_read_b64_tr_b16 v[30:31], v73 offset:54272
    s_waitcnt lgkmcnt(5)
    v_mfma_f32_32x32x16_bf16 v[48:63], v[144:147], v[20:23], v[48:63]
    s_setprio 0
    s_add_u32 m0, s45, 81920
    s_mul_i32 s43, s42, 1920
    buffer_load_dwordx4 v66, s[12:15], s43 offen  lds
    s_cmp_lt_u32 s36, 4
    s_cbranch_scc1 F_ifw28
    s_waitcnt lgkmcnt(0)
    v_mfma_f32_16x16x32_bf16 v[88:91], v[84:87], v[236:239], 0
    v_mfma_f32_16x16x32_bf16 v[88:91], v[84:87], v[240:243], v[88:91]
    v_mfma_f32_16x16x32_bf16 v[88:91], v[84:87], v[244:247], v[88:91]
    v_mfma_f32_16x16x32_bf16 v[88:91], v[84:87], v[248:251], v[88:91]
    ds_read_b64_tr_b16 v[236:237], v94 offset:8192
    ds_read_b64_tr_b16 v[238:239], v94 offset:8704
    ds_read_b64_tr_b16 v[240:241], v94 offset:10240
    ds_read_b64_tr_b16 v[242:243], v94 offset:10752
    ds_read_b64_tr_b16 v[244:245], v94 offset:12288
    ds_read_b64_tr_b16 v[246:247], v94 offset:12800
    ds_read_b64_tr_b16 v[248:249], v94 offset:14336
    ds_read_b64_tr_b16 v[250:251], v94 offset:14848
F_ifw28:
    s_setprio 1
    s_waitcnt lgkmcnt(2)
    v_mfma_f32_32x32x16_bf16 v[32:47], v[148:151], v[24:27], v[32:47]
    ds_read_b128 v[152:155], v70 offset:49152
    ds_read_b64_tr_b16 v[16:17], v72 offset:57344
    ds_read_b64_tr_b16 v[18:19], v72 offset:58368
    ds_read_b64_tr_b16 v[20:21], v73 offset:57344
    ds_read_b64_tr_b16 v[22:23], v73 offset:58368
    s_waitcnt lgkmcnt(5)
    v_mfma_f32_32x32x16_bf16 v[48:63], v[148:151], v[28:31], v[48:63]
    s_setprio 0
    s_add_u32 m0, s45, 82944
    s_nop 0
    buffer_load_dwordx4 v67, s[12:15], s43 offen  lds
    s_cmp_lt_u32 s36, 4
    s_cbranch_scc1 F_ifw29
    s_waitcnt lgkmcnt(0)
    v_mfma_f32_16x16x32_bf16 v[88:91], v[84:87], v[236:239], v[88:91]
    v_mfma_f32_16x16x32_bf16 v[88:91], v[84:87], v[240:243], v[88:91]
    v_mfma_f32_16x16x32_bf16 v[88:91], v[84:87], v[244:247], v[88:91]
    v_mfma_f32_16x16x32_bf16 v[88:91], v[84:87], v[248:251], v[88:91]
    s_nop 7
    v_lshlrev_b32 v89, 2, v0
    s_mov_b64 exec, 0xffffffff
    buffer_store_dword v88, v89, s[24:27], s53 offen sc0 sc1
    s_mov_b64 exec, -1
F_ifw29:
    v_mul_f32 v79, 0x3acccccd, v79
    v_mul_f32 v80, 0x3acccccd, v80
    v_fma_f32 v80, -v79, v79, v80
    v_max_f32 v80, 0, v80
    ds_read_b128 v[156:159], v71 offset:49152
    ds_read_b64_tr_b16 v[24:25], v72 offset:61440
    ds_read_b64_tr_b16 v[26:27], v72 offset:62464
    ds_read_b64_tr_b16 v[28:29], v73 offset:61440
    ds_read_b64_tr_b16 v[30:31], v73 offset:62464
    s_setprio 1
    s_waitcnt lgkmcnt(7)
    v_mfma_f32_32x32x16_bf16 v[32:47], v[152:155], v[16:19], v[32:47]
    s_add_u32 m0, s45, 32768
    s_add_u32 s42, s42, 128
    s_cmp_eq_u32 s42, 1280
    s_cselect_b32 s42, 0, s42
    buffer_load_dwordx4 v64, s[8:11], s42 offen  lds
    v_cvt_pk_bf16_f32 v83, -v79, -v79
    v_cvt_pk_bf16_f32 v80, v80, v80
    v_lshlrev_b32 v80, 16, v80
    s_waitcnt lgkmcnt(5)
    v_mfma_f32_32x32x16_bf16 v[48:63], v[152:155], v[20:23], v[48:63]
    s_waitcnt lgkmcnt(0)
    s_waitcnt vmcnt(5)
    s_barrier
    v_mfma_f32_32x32x16_bf16 v[32:47], v[156:159], v[24:27], v[32:47]
    ds_read_b128 v[160:163], v68 offset:0
    ds_read_b64_tr_b16 v[16:17], v72 offset:0
    ds_read_b64_tr_b16 v[18:19], v72 offset:1024
    ds_read_b64_tr_b16 v[20:21], v73 offset:0
    ds_read_b64_tr_b16 v[22:23], v73 offset:1024
    v_mfma_f32_32x32x16_bf16 v[48:63], v[156:159], v[28:31], v[48:63]
    s_setprio 0
    s_add_u32 m0, s45, 33792
    s_nop 0
    buffer_load_dwordx4 v65, s[8:11], s42 offen  lds
    v_add_f32 v80, 0x3727c5ac, v80
    v_cvt_pk_bf16_f32 v80, v80, v80
    v_lshlrev_b32 v80, 16, v80
    v_sqrt_f32 v80, v80
    s_nop 0
    v_cvt_pk_bf16_f32 v80, v80, v80
    v_lshlrev_b32 v80, 16, v80
    v_rcp_f32 v82, v80
    s_mov_b32 s4, 0
    s_brev_b32 s5, 1
    s_mov_b64 exec, s[4:5]
    buffer_store_dwordx2 v[82:83], off, s[24:27], s54 sc0 sc1
    s_mov_b64 exec, -1
    s_setprio 1
    s_waitcnt lgkmcnt(2)
    v_mfma_f32_32x32x16_bf16 v[32:47], v[160:163], v[16:19], v[32:47]
    ds_read_b128 v[164:167], v69 offset:0
    ds_read_b64_tr_b16 v[24:25], v72 offset:4096
    ds_read_b64_tr_b16 v[26:27], v72 offset:5120
    ds_read_b64_tr_b16 v[28:29], v73 offset:4096
    ds_read_b64_tr_b16 v[30:31], v73 offset:5120
    s_waitcnt lgkmcnt(5)
    v_mfma_f32_32x32x16_bf16 v[48:63], v[160:163], v[20:23], v[48:63]
    s_setprio 0
    s_add_u32 m0, s45, 98304
    s_mul_i32 s43, s42, 1920
    buffer_load_dwordx4 v66, s[12:15], s43 offen  lds
    s_mov_b32 s16, s64
    s_and_b32 s17, s65, 0xffff
    s_mov_b32 s18, 1966080
    s_mov_b32 s19, 0x00020000
    s_mov_b32 s20, s66
    s_and_b32 s21, s67, 0xffff
    s_mov_b32 s22, 1966080
    s_mov_b32 s23, 0x00020000
    v_lshrrev_b32 v13, 5, v0
    s_setprio 1
    s_waitcnt lgkmcnt(2)
    v_mfma_f32_32x32x16_bf16 v[32:47], v[164:167], v[24:27], v[32:47]
    ds_read_b128 v[168:171], v70 offset:0
    ds_read_b64_tr_b16 v[16:17], v72 offset:8192
    ds_read_b64_tr_b16 v[18:19], v72 offset:9216
    ds_read_b64_tr_b16 v[20:21], v73 offset:8192
    ds_read_b64_tr_b16 v[22:23], v73 offset:9216
    s_waitcnt lgkmcnt(5)
    v_mfma_f32_32x32x16_bf16 v[48:63], v[164:167], v[28:31], v[48:63]
    s_setprio 0
    s_add_u32 m0, s45, 99328
    s_nop 0
    buffer_load_dwordx4 v67, s[12:15], s43 offen  lds
    v_bfe_u32 v12, v0, 2, 2
    v_lshl_add_u32 v14, v13, 3, v12
    v_bfe_u32 v15, v0, 4, 1
    v_and_b32 v12, 3, v0
    v_lshlrev_b32 v4, 7, v14
    v_lshl_add_u32 v4, v15, 16, v4
    v_lshl_add_u32 v4, v12, 3, v4
    ds_read_b128 v[172:175], v71 offset:0
    ds_read_b64_tr_b16 v[24:25], v72 offset:12288
    ds_read_b64_tr_b16 v[26:27], v72 offset:13312
    ds_read_b64_tr_b16 v[28:29], v73 offset:12288
    ds_read_b64_tr_b16 v[30:31], v73 offset:13312
    s_setprio 1
    s_waitcnt lgkmcnt(7)
    v_mfma_f32_32x32x16_bf16 v[32:47], v[168:171], v[16:19], v[32:47]
    s_add_u32 m0, s45, 49152
    s_add_u32 s42, s42, 128
    s_cmp_eq_u32 s42, 1280
    s_cselect_b32 s42, 0, s42
    buffer_load_dwordx4 v64, s[8:11], s42 offen  lds
    s_waitcnt lgkmcnt(5)
    v_mfma_f32_32x32x16_bf16 v[48:63], v[168:171], v[20:23], v[48:63]
    s_waitcnt lgkmcnt(0)
    s_waitcnt vmcnt(6)
    s_barrier
    v_mfma_f32_32x32x16_bf16 v[32:47], v[172:175], v[24:27], v[32:47]
    ds_read_b128 v[176:179], v68 offset:16384
    ds_read_b64_tr_b16 v[16:17], v72 offset:16384
    ds_read_b64_tr_b16 v[18:19], v72 offset:17408
    ds_read_b64_tr_b16 v[20:21], v73 offset:16384
    ds_read_b64_tr_b16 v[22:23], v73 offset:17408
    v_mfma_f32_32x32x16_bf16 v[48:63], v[172:175], v[28:31], v[48:63]
    s_setprio 0
    s_add_u32 m0, s45, 50176
    s_nop 0
    buffer_load_dwordx4 v65, s[8:11], s42 offen  lds
    v_bfe_u32 v12, v0, 3, 1
    v_lshlrev_b32 v12, 1, v12
    v_xor_b32 v12, v12, v15
    s_lshl_b32 s4, s38, 1
    v_xor_b32 v12, s4, v12
    v_lshl_add_u32 v4, v12, 5, v4
    v_xor_b32 v5, 32, v4
    s_setprio 1
    s_waitcnt lgkmcnt(2)
    v_mfma_f32_32x32x16_bf16 v[32:47], v[176:179], v[16:19], v[32:47]
    ds_read_b128 v[180:183], v69 offset:16384
    ds_read_b64_tr_b16 v[24:25], v72 offset:20480
    ds_read_b64_tr_b16 v[26:27], v72 offset:21504
    ds_read_b64_tr_b16 v[28:29], v73 offset:20480
    ds_read_b64_tr_b16 v[30:31], v73 offset:21504
    s_waitcnt lgkmcnt(5)
    v_mfma_f32_32x32x16_bf16 v[48:63], v[176:179], v[20:23], v[48:63]
    s_setprio 0
    s_add_u32 m0, s45, 114688
    s_mul_i32 s43, s42, 1920
    buffer_load_dwordx4 v66, s[12:15], s43 offen  lds
    v_readfirstlane_b32 s32, v252
    v_readfirstlane_b32 s33, v253
    s_cmp_eq_u32 s32, 0
    s_cbranch_scc1 F_nspin24
F_nz23:
    v_lshrrev_b32 v12, 3, v0
    s_lshl_b32 s4, s36, 3
    v_add_u32 v12, s4, v12
    s_setprio 1
    s_waitcnt lgkmcnt(2)
    v_mfma_f32_32x32x16_bf16 v[32:47], v[180:183], v[24:27], v[32:47]
    ds_read_b128 v[184:187], v70 offset:16384
    ds_read_b64_tr_b16 v[16:17], v72 offset:24576
    ds_read_b64_tr_b16 v[18:19], v72 offset:25600
    ds_read_b64_tr_b16 v[20:21], v73 offset:24576
    ds_read_b64_tr_b16 v[22:23], v73 offset:25600
    s_waitcnt lgkmcnt(5)
    v_mfma_f32_32x32x16_bf16 v[48:63], v[180:183], v[28:31], v[48:63]
    s_setprio 0
    s_add_u32 m0, s45, 115712
    s_nop 0
    buffer_load_dwordx4 v67, s[12:15], s43 offen  lds
    v_mul_u32_u24 v12, 3072, v12
    s_mul_i32 s47, s40, 192
    s_and_b32 s5, s40, 1
    s_lshl_b32 s46, s5, 6
    s_add_u32 s46, s46, s47
    v_add_u32 v12, s46, v12
    s_andn2_b32 s5, 1, s40
    s_lshl_b32 s5, s5, 7
    s_add_u32 s47, s47, s5
    ds_read_b128 v[188:191], v71 offset:16384
    ds_read_b64_tr_b16 v[24:25], v72 offset:28672
    ds_read_b64_tr_b16 v[26:27], v72 offset:29696
    ds_read_b64_tr_b16 v[28:29], v73 offset:28672
    ds_read_b64_tr_b16 v[30:31], v73 offset:29696
    s_setprio 1
    s_waitcnt lgkmcnt(7)
    v_mfma_f32_32x32x16_bf16 v[32:47], v[184:187], v[16:19], v[32:47]
    s_add_u32 m0, s45, 0
    s_add_u32 s42, s42, 128
    s_cmp_eq_u32 s42, 1280
    s_cselect_b32 s42, 0, s42
    buffer_load_dwordx4 v64, s[8:11], s42 offen  lds
    s_waitcnt lgkmcnt(5)
    v_mfma_f32_32x32x16_bf16 v[48:63], v[184:187], v[20:23], v[48:63]
    s_waitcnt lgkmcnt(0)
    s_waitcnt vmcnt(5)
    s_waitcnt vmcnt(7)
    s_waitcnt vmcnt(10)
    s_barrier
    v_mfma_f32_32x32x16_bf16 v[32:47], v[188:191], v[24:27], v[32:47]
    ds_read_b128 v[192:195], v68 offset:32768
    ds_read_b64_tr_b16 v[16:17], v72 offset:32768
    ds_read_b64_tr_b16 v[18:19], v72 offset:33792
    ds_read_b64_tr_b16 v[20:21], v73 offset:32768
    ds_read_b64_tr_b16 v[22:23], v73 offset:33792
    v_mfma_f32_32x32x16_bf16 v[48:63], v[188:191], v[28:31], v[48:63]
    s_setprio 0
    s_add_u32 m0, s45, 1024
    s_nop 0
    buffer_load_dwordx4 v65, s[8:11], s42 offen  lds
    s_cmp_lg_u32 s36, 0
    s_cbranch_scc1 F_pub30
    s_lshl_b32 s4, s2, 5
    s_add_u32 s4, s4, 19678848
    s_add_u32 s5, s32, 1
    v_mov_b32 v24, s5
    v_mov_b32 v25, s33
    s_mov_b64 exec, 1
    buffer_store_dwordx2 v[24:25], off, s[24:27], s4 sc0 sc1
    s_mov_b64 exec, -1
F_pub30:
    v_lshlrev_b32 v15, 2, v15
    v_and_b32 v14, 7, v0
    s_setprio 1
    s_waitcnt lgkmcnt(2)
    v_mfma_f32_32x32x16_bf16 v[32:47], v[192:195], v[16:19], v[32:47]
    ds_read_b128 v[196:199], v69 offset:32768
    ds_read_b64_tr_b16 v[24:25], v72 offset:36864
    ds_read_b64_tr_b16 v[26:27], v72 offset:37888
    ds_read_b64_tr_b16 v[28:29], v73 offset:36864
    ds_read_b64_tr_b16 v[30:31], v73 offset:37888
    s_waitcnt lgkmcnt(5)
    v_mfma_f32_32x32x16_bf16 v[48:63], v[192:195], v[20:23], v[48:63]
    s_setprio 0
    s_add_u32 m0, s45, 65536
    s_mul_i32 s43, s42, 1920
    buffer_load_dwordx4 v66, s[12:15], s43 offen  lds
    v_xor_b32 v14, v14, v15
    v_lshl_add_u32 v2, v14, 4, v12
    v_xor_b32 v14, 2, v14
    v_lshl_add_u32 v3, v14, 4, v12
    s_mul_i32 s44, s3, 196608
    s_lshl_b32 s48, s39, 2
    s_add_u32 s48, s48, s37
    s_setprio 1
    s_waitcnt lgkmcnt(2)
    v_mfma_f32_32x32x16_bf16 v[32:47], v[196:199], v[24:27], v[32:47]
    ds_read_b128 v[200:203], v70 offset:32768
    ds_read_b64_tr_b16 v[16:17], v72 offset:40960
    ds_read_b64_tr_b16 v[18:19], v72 offset:41984
    ds_read_b64_tr_b16 v[20:21], v73 offset:40960
    ds_read_b64_tr_b16 v[22:23], v73 offset:41984
    s_waitcnt lgkmcnt(5)
    v_mfma_f32_32x32x16_bf16 v[48:63], v[196:199], v[28:31], v[48:63]
    s_setprio 0
    s_add_u32 m0, s45, 66560
    s_nop 0
    buffer_load_dwordx4 v67, s[12:15], s43 offen  lds
    s_lshl_b32 s4, s36, 10
    s_add_u32 s4, s4, 19678848
    v_and_b32 v12, 31, v0
    v_lshl_add_u32 v11, v12, 5, s4
    s_mul_i32 s4, s48, 1280
    s_add_u32 s75, s4, 5242880
    ds_read_b128 v[204:207], v71 offset:32768
    ds_read_b64_tr_b16 v[24:25], v72 offset:45056
    ds_read_b64_tr_b16 v[26:27], v72 offset:46080
    ds_read_b64_tr_b16 v[28:29], v73 offset:45056
    ds_read_b64_tr_b16 v[30:31], v73 offset:46080
    s_setprio 1
    s_waitcnt lgkmcnt(7)
    v_mfma_f32_32x32x16_bf16 v[32:47], v[200:203], v[16:19], v[32:47]
    s_add_u32 m0, s45, 16384
    s_add_u32 s42, s42, 128
    s_cmp_eq_u32 s42, 1280
    s_cselect_b32 s42, 0, s42
    buffer_load_dwordx4 v64, s[8:11], s42 offen  lds
    s_waitcnt lgkmcnt(5)
    v_mfma_f32_32x32x16_bf16 v[48:63], v[200:203], v[20:23], v[48:63]
    s_waitcnt lgkmcnt(0)
    s_waitcnt vmcnt(5)
    s_barrier
    v_mfma_f32_32x32x16_bf16 v[32:47], v[204:207], v[24:27], v[32:47]
    ds_read_b128 v[208:211], v68 offset:49152
    ds_read_b64_tr_b16 v[16:17], v72 offset:49152
    ds_read_b64_tr_b16 v[18:19], v72 offset:50176
    ds_read_b64_tr_b16 v[20:21], v73 offset:49152
    ds_read_b64_tr_b16 v[22:23], v73 offset:50176
    v_mfma_f32_32x32x16_bf16 v[48:63], v[204:207], v[28:31], v[48:63]
    s_setprio 0
    s_add_u32 m0, s45, 17408
    s_nop 0
    buffer_load_dwordx4 v65, s[8:11], s42 offen  lds
    s_lshl_b32 s4, s38, 1
    s_add_u32 s4, s4, s41
    s_sub_u32 s4, s4, 40
    s_lshl_b32 s4, s4, 5
    v_and_b32 v12, 31, v0
    v_add_u32 v12, s4, v12
    v_mul_u32_u24 v14, 3277, v12
    v_lshrrev_b32 v14, 16, v14
    v_mul_u32_u24 v15, 20, v14
    v_sub_u32 v12, v12, v15
    s_setprio 1
    s_waitcnt lgkmcnt(2)
    v_mfma_f32_32x32x16_bf16 v[32:47], v[208:211], v[16:19], v[32:47]
    ds_read_b128 v[212:215], v69 offset:49152
    ds_read_b64_tr_b16 v[24:25], v72 offset:53248
    ds_read_b64_tr_b16 v[26:27], v72 offset:54272
    ds_read_b64_tr_b16 v[28:29], v73 offset:53248
    ds_read_b64_tr_b16 v[30:31], v73 offset:54272
    s_waitcnt lgkmcnt(5)
    v_mfma_f32_32x32x16_bf16 v[48:63], v[208:211], v[20:23], v[48:63]
    s_setprio 0
    s_add_u32 m0, s45, 81920
    s_mul_i32 s43, s42, 1920
    buffer_load_dwordx4 v66, s[12:15], s43 offen  lds
    v_cmp_gt_u32 s[34:35], 8, v12
    v_mul_u32_u24 v14, 81920, v14
    v_lshl_add_u32 v14, v12, 4, v14
    v_lshrrev_b32 v12, 5, v0
    v_mul_u32_u24 v12, 320, v12
    v_add_u32 v10, v12, v14
    s_setprio 1
    s_waitcnt lgkmcnt(2)
    v_mfma_f32_32x32x16_bf16 v[32:47], v[212:215], v[24:27], v[32:47]
    ds_read_b128 v[216:219], v70 offset:49152
    ds_read_b64_tr_b16 v[16:17], v72 offset:57344
    ds_read_b64_tr_b16 v[18:19], v72 offset:58368
    ds_read_b64_tr_b16 v[20:21], v73 offset:57344
    ds_read_b64_tr_b16 v[22:23], v73 offset:58368
    s_waitcnt lgkmcnt(5)
    v_mfma_f32_32x32x16_bf16 v[48:63], v[212:215], v[28:31], v[48:63]
    s_setprio 0
    s_add_u32 m0, s45, 82944
    s_nop 0
    buffer_load_dwordx4 v67, s[12:15], s43 offen  lds
    s_add_u32 m0, s55, 32768
    s_add_u32 s44, s44, 196608
    s_cmp_eq_u32 s44, 1966080
    s_cselect_b32 s44, 0, s44
    buffer_load_dwordx4 v2, s[16:19], s44 offen  lds
    ds_read_b128 v[220:223], v71 offset:49152
    ds_read_b64_tr_b16 v[24:25], v72 offset:61440
    ds_read_b64_tr_b16 v[26:27], v72 offset:62464
    ds_read_b64_tr_b16 v[28:29], v73 offset:61440
    ds_read_b64_tr_b16 v[30:31], v73 offset:62464
    s_setprio 1
    s_waitcnt lgkmcnt(7)
    v_mfma_f32_32x32x16_bf16 v[32:47], v[216:219], v[16:19], v[32:47]
    s_add_u32 m0, s55, 98304
    s_nop 0
    buffer_load_dwordx4 v3, s[20:23], s44 offen  lds
    s_waitcnt lgkmcnt(5)
    v_mfma_f32_32x32x16_bf16 v[48:63], v[216:219], v[20:23], v[48:63]
    s_waitcnt lgkmcnt(0)
    s_waitcnt vmcnt(6)
    s_barrier
    v_mfma_f32_32x32x16_bf16 v[32:47], v[220:223], v[24:27], v[32:47]
    ds_read_b128 v[224:227], v68 offset:0
    ds_read_b64_tr_b16 v[16:17], v72 offset:0
    ds_read_b64_tr_b16 v[18:19], v72 offset:1024
    ds_read_b64_tr_b16 v[20:21], v73 offset:0
    ds_read_b64_tr_b16 v[22:23], v73 offset:1024
    v_mfma_f32_32x32x16_bf16 v[48:63], v[220:223], v[28:31], v[48:63]
    s_setprio 0
    s_cmp_ge_u32 s36, 4
    s_cbranch_scc1 F_ifw31
    s_lshl_b32 s4, s36, 6
    v_add_u32 v12, s4, v0
    v_lshrrev_b32 v13, 5, v12
    v_mul_u32_u24 v13, 19456, v13
    v_lshl_add_u32 v13, v12, 4, v13
F_ifw31:
    s_cmp_lt_u32 s36, 4
    s_cbranch_scc1 F_ifw32
    s_lshl_b32 s4, s37, 6
    v_add_u32 v12, s4, v0
    v_mul_u32_u24 v13, 2731, v12
    v_lshrrev_b32 v13, 16, v13
    v_lshrrev_b32 v14, 1, v13
F_ifw32:
    s_setprio 1
    s_waitcnt lgkmcnt(2)
    v_mfma_f32_32x32x16_bf16 v[32:47], v[224:227], v[16:19], v[32:47]
    ds_read_b128 v[228:231], v69 offset:0
    ds_read_b64_tr_b16 v[24:25], v72 offset:4096
    ds_read_b64_tr_b16 v[26:27], v72 offset:5120
    ds_read_b64_tr_b16 v[28:29], v73 offset:4096
    ds_read_b64_tr_b16 v[30:31], v73 offset:5120
    s_waitcnt lgkmcnt(5)
    v_mfma_f32_32x32x16_bf16 v[48:63], v[224:227], v[20:23], v[48:63]
    s_setprio 0
    s_add_u32 m0, s55, 40960
    s_add_u32 s44, s44, 196608
    s_cmp_eq_u32 s44, 1966080
    s_cselect_b32 s44, 0, s44
    buffer_load_dwordx4 v2, s[16:19], s44 offen  lds
    s_cmp_ge_u32 s36, 4
    s_cbranch_scc1 F_ifw33
    s_lshl_b32 s4, s41, 7
    s_add_u32 s4, s4, 19578880
    v_add_u32 v13, s4, v13
    s_lshl_b32 s4, s39, 10
    s_add_u32 s4, s4, 19559936
    v_lshl_add_u32 v14, v12, 4, s4
F_ifw33:
    s_cmp_lt_u32 s36, 4
    s_cbranch_scc1 F_ifw34
    v_mul_u32_u24 v14, 7680, v14
    v_mul_u32_u24 v13, 5760, v13
    v_add_u32 v13, v13, v14
    v_lshl_add_u32 v13, v12, 4, v13
F_ifw34:
    s_setprio 1
    s_waitcnt lgkmcnt(2)
    v_mfma_f32_32x32x16_bf16 v[32:47], v[228:231], v[24:27], v[32:47]
    ds_read_b128 v[232:235], v70 offset:0
    ds_read_b64_tr_b16 v[16:17], v72 offset:8192
    ds_read_b64_tr_b16 v[18:19], v72 offset:9216
    ds_read_b64_tr_b16 v[20:21], v73 offset:8192
    ds_read_b64_tr_b16 v[22:23], v73 offset:9216
    s_waitcnt lgkmcnt(5)
    v_mfma_f32_32x32x16_bf16 v[48:63], v[228:231], v[28:31], v[48:63]
    s_setprio 0
    s_add_u32 m0, s55, 106496
    s_nop 0
    buffer_load_dwordx4 v3, s[20:23], s44 offen  lds
    s_mul_i32 s51, s48, 136
    s_add_u32 s51, s51, s38
    s_lshr_b32 s4, s47, 5
    s_add_u32 s52, s4, s51
    s_lshl_b32 s52, s52, 10
    s_add_u32 s52, s52, 7864320
    s_lshr_b32 s4, s46, 5
    s_add_u32 s51, s51, s4
    ds_read_b128 v[236:239], v71 offset:0
    ds_read_b64_tr_b16 v[24:25], v72 offset:12288
    ds_read_b64_tr_b16 v[26:27], v72 offset:13312
    ds_read_b64_tr_b16 v[28:29], v73 offset:12288
    ds_read_b64_tr_b16 v[30:31], v73 offset:13312
    s_setprio 1
    s_waitcnt lgkmcnt(7)
    v_mfma_f32_32x32x16_bf16 v[32:47], v[232:235], v[16:19], v[32:47]
    s_add_u32 m0, s45, 131072
    s_nop 0
    buffer_load_dwordx4 v255, s[76:79], s0 offen lds
    s_add_u32 m0, s45, 132096
    s_add_u32 s4, s0, s1
    buffer_load_dwordx4 v255, s[76:79], s4 offen lds
    s_waitcnt lgkmcnt(5)
    v_mfma_f32_32x32x16_bf16 v[48:63], v[232:235], v[20:23], v[48:63]
    s_waitcnt lgkmcnt(0)
    s_waitcnt vmcnt(6)
    s_barrier
    v_mfma_f32_32x32x16_bf16 v[32:47], v[236:239], v[24:27], v[32:47]
    ds_read_b128 v[240:243], v68 offset:16384
    ds_read_b64_tr_b16 v[16:17], v72 offset:16384
    ds_read_b64_tr_b16 v[18:19], v72 offset:17408
    ds_read_b64_tr_b16 v[20:21], v73 offset:16384
    ds_read_b64_tr_b16 v[22:23], v73 offset:17408
    v_mfma_f32_32x32x16_bf16 v[48:63], v[236:239], v[28:31], v[48:63]
    s_branch F_pg4k
.p2align 12
F_pg4:
    s_setpc_b64 s[6:7]
F_pg4k:
    s_setprio 0
    s_add_u32 m0, s55, 49152
    s_add_u32 s44, s44, 196608
    s_cmp_eq_u32 s44, 1966080
    s_cselect_b32 s44, 0, s44
    buffer_load_dwordx4 v2, s[16:19], s44 offen  lds
    buffer_load_dwordx2 v[94:95], v11, s[24:27], 0 offen sc1
    s_cmp_ge_u32 s36, 4
    s_cbranch_scc1 F_ifw35
    v_cmp_gt_u32 vcc, 160, v12
    s_nop 1
    v_cndmask_b32 v13, v14, v13, vcc
    v_mov_b32 v14, 1073741824
    v_cmp_gt_u32 vcc, 224, v12
    s_nop 1
    v_cndmask_b32 v12, v14, v13, vcc
F_ifw35:
    s_cmp_lt_u32 s36, 4
    s_cbranch_scc1 F_ifw36
    s_mul_i32 s4, s40, 384
    s_add_u32 s4, s4, 19586560
    v_add_u32 v13, s4, v13
    v_mov_b32 v14, 1073741824
    v_cmp_gt_u32 vcc, 240, v12
    s_nop 1
    v_cndmask_b32 v12, v14, v13, vcc
F_ifw36:
    s_setprio 1
    s_waitcnt lgkmcnt(2)
    v_mfma_f32_32x32x16_bf16 v[32:47], v[240:243], v[16:19], v[32:47]
    ds_read_b128 v[244:247], v69 offset:16384
    ds_read_b64_tr_b16 v[24:25], v72 offset:20480
    ds_read_b64_tr_b16 v[26:27], v72 offset:21504
    ds_read_b64_tr_b16 v[28:29], v73 offset:20480
    ds_read_b64_tr_b16 v[30:31], v73 offset:21504
    s_waitcnt lgkmcnt(5)
    v_mfma_f32_32x32x16_bf16 v[48:63], v[240:243], v[20:23], v[48:63]
    s_setprio 0
    s_add_u32 m0, s55, 114688
    s_nop 0
    buffer_load_dwordx4 v3, s[20:23], s44 offen  lds
    s_add_u32 s51, s51, s38
    s_lshl_b32 s51, s51, 10
    s_add_u32 s51, s51, 7864320
    s_and_b32 s56, s2, 7
    s_lshl_b32 s56, s56, 2
    s_bfe_u32 s4, s2, 0x20003
    s_add_u32 s56, s56, s4
    s_lshr_b32 s57, s2, 5
    s_and_b32 s60, s56, 1
    s_setprio 1
    s_waitcnt lgkmcnt(2)
    v_mfma_f32_32x32x16_bf16 v[32:47], v[244:247], v[24:27], v[32:47]
    ds_read_b128 v[248:251], v70 offset:16384
    ds_read_b64_tr_b16 v[16:17], v72 offset:24576
    ds_read_b64_tr_b16 v[18:19], v72 offset:25600
    ds_read_b64_tr_b16 v[20:21], v73 offset:24576
    ds_read_b64_tr_b16 v[22:23], v73 offset:25600
    s_waitcnt lgkmcnt(5)
    v_mfma_f32_32x32x16_bf16 v[48:63], v[244:247], v[28:31], v[48:63]
    s_setprio 0
    s_add_u32 m0, s55, 57344
    s_add_u32 s44, s44, 196608
    s_cmp_eq_u32 s44, 1966080
    s_cselect_b32 s44, 0, s44
    buffer_load_dwordx4 v2, s[16:19], s44 offen  lds
    s_lshr_b32 s4, s56, 1
    s_mul_i32 s4, s4, 5
    s_add_u32 s59, s4, 2
    s_mul_i32 s58, s60, 3
    s_add_u32 s58, s58, s4
    ds_read_b128 v[252:255], v71 offset:16384
    ds_read_b64_tr_b16 v[24:25], v72 offset:28672
    ds_read_b64_tr_b16 v[26:27], v72 offset:29696
    ds_read_b64_tr_b16 v[28:29], v73 offset:28672
    ds_read_b64_tr_b16 v[30:31], v73 offset:29696
    s_setprio 1
    s_waitcnt lgkmcnt(7)
    v_mfma_f32_32x32x16_bf16 v[32:47], v[248:251], v[16:19], v[32:47]
    s_add_u32 m0, s55, 122880
    s_nop 0
    buffer_load_dwordx4 v3, s[20:23], s44 offen  lds
    s_sub_u32 s61, s59, s58
    s_lshl_b32 s61, s61, 15
    s_waitcnt lgkmcnt(5)
    v_mfma_f32_32x32x16_bf16 v[48:63], v[248:251], v[20:23], v[48:63]
    s_waitcnt lgkmcnt(0)
    s_waitcnt vmcnt(9)
    s_barrier
    v_mfma_f32_32x32x16_bf16 v[32:47], v[252:255], v[24:27], v[32:47]
    ds_read_b64_tr_b16 v[16:17], v4 offset:32768
    ds_read_b64_tr_b16 v[18:19], v4 offset:33280
    ds_read_b64_tr_b16 v[20:21], v5 offset:32768
    ds_read_b64_tr_b16 v[22:23], v5 offset:33280
    v_mfma_f32_32x32x16_bf16 v[48:63], v[252:255], v[28:31], v[48:63]
    s_setprio 0
    s_add_u32 m0, s55, 0
    s_add_u32 s44, s44, 196608
    s_cmp_eq_u32 s44, 1966080
    s_cselect_b32 s44, 0, s44
    buffer_load_dwordx4 v2, s[16:19], s44 offen  lds
    s_add_u32 s4, s32, 1
    s_waitcnt vmcnt(4)
    v_xor_b32 v95, s33, v95
    v_subrev_u32 v94, s4, v94
    v_lshrrev_b32 v94, 3, v94
    v_or_b32 v95, v95, v94
    v_cmp_ne_u32 vcc, 0, v95
    s_nop 4
    s_cbranch_vccnz F_spin26
F_ok25:
    s_setprio 1
    s_waitcnt lgkmcnt(2)
    v_mfma_f32_32x32x16_bf16 v[64:79], v[16:19], v[96:99], 0
    ds_read_b64_tr_b16 v[24:25], v4 offset:34816
    ds_read_b64_tr_b16 v[26:27], v4 offset:35328
    ds_read_b64_tr_b16 v[28:29], v5 offset:34816
    ds_read_b64_tr_b16 v[30:31], v5 offset:35328
    s_waitcnt lgkmcnt(4)
    v_mfma_f32_32x32x16_bf16 v[80:95], v[20:23], v[96:99], 0
    s_setprio 0
    s_add_u32 m0, s55, 65536
    s_nop 0
    buffer_load_dwordx4 v3, s[20:23], s44 offen  lds
    s_mov_b32 s69, 0
    s_add_u32 s62, s58, 80
    s_lshl_b32 s62, s62, 15
    s_mul_i32 s4, s38, 12288
    s_add_u32 s62, s62, s4
    s_add_u32 s62, s62, s55
    s_mul_i32 s63, s56, 81920
    s_mul_i32 s4, s38, 40960
    s_add_u32 s63, s63, s4
    s_setprio 1
    s_waitcnt lgkmcnt(2)
    v_mfma_f32_32x32x16_bf16 v[64:79], v[24:27], v[100:103], v[64:79]
    ds_read_b64_tr_b16 v[16:17], v4 offset:36864
    ds_read_b64_tr_b16 v[18:19], v4 offset:37376
    ds_read_b64_tr_b16 v[20:21], v5 offset:36864
    ds_read_b64_tr_b16 v[22:23], v5 offset:37376
    s_waitcnt lgkmcnt(4)
    v_mfma_f32_32x32x16_bf16 v[80:95], v[28:31], v[100:103], v[80:95]
    s_setprio 0
    s_add_u32 m0, s55, 8192
    s_add_u32 s44, s44, 196608
    s_cmp_eq_u32 s44, 1966080
    s_cselect_b32 s44, 0, s44
    buffer_load_dwordx4 v2, s[16:19], s44 offen  lds
    s_mul_i32 s4, s37, 2560
    s_add_u32 s63, s63, s4
    s_add_u32 s63, s63, 5242880
    s_mov_b32 s67, 0
    ds_read_b64_tr_b16 v[24:25], v4 offset:38912
    ds_read_b64_tr_b16 v[26:27], v4 offset:39424
    ds_read_b64_tr_b16 v[28:29], v5 offset:38912
    ds_read_b64_tr_b16 v[30:31], v5 offset:39424
    s_setprio 1
    s_waitcnt lgkmcnt(6)
    v_mfma_f32_32x32x16_bf16 v[64:79], v[16:19], v[104:107], v[64:79]
    s_add_u32 m0, s55, 73728
    s_nop 0
    buffer_load_dwordx4 v3, s[20:23], s44 offen  lds
    s_waitcnt lgkmcnt(4)
    v_mfma_f32_32x32x16_bf16 v[80:95], v[20:23], v[104:107], v[80:95]
    s_waitcnt lgkmcnt(0)
    s_waitcnt vmcnt(11)
    s_barrier
    v_mfma_f32_32x32x16_bf16 v[64:79], v[24:27], v[108:111], v[64:79]
    ds_read_b64_tr_b16 v[16:17], v4 offset:40960
    ds_read_b64_tr_b16 v[18:19], v4 offset:41472
    ds_read_b64_tr_b16 v[20:21], v5 offset:40960
    ds_read_b64_tr_b16 v[22:23], v5 offset:41472
    v_mfma_f32_32x32x16_bf16 v[80:95], v[28:31], v[108:111], v[80:95]
    s_setprio 0
    s_add_u32 m0, s55, 16384
    s_add_u32 s44, s44, 196608
    s_cmp_eq_u32 s44, 1966080
    s_cselect_b32 s44, 0, s44
    buffer_load_dwordx4 v2, s[16:19], s44 offen  lds
    s_add_u32 m0, s55, 147456
    s_nop 0
    buffer_load_dwordx4 v12, s[24:27], 0 offen sc1 lds
    s_lshl_b32 s5, s38, 16
    s_add_u32 s5, s5, 24576
    s_mul_i32 s4, s37, 3072
    s_add_u32 s64, s5, s4
    s_setprio 1
    s_waitcnt lgkmcnt(2)
    v_mfma_f32_32x32x16_bf16 v[64:79], v[16:19], v[112:115], v[64:79]
    ds_read_b64_tr_b16 v[24:25], v4 offset:43008
    ds_read_b64_tr_b16 v[26:27], v4 offset:43520
    ds_read_b64_tr_b16 v[28:29], v5 offset:43008
    ds_read_b64_tr_b16 v[30:31], v5 offset:43520
    s_waitcnt lgkmcnt(4)
    v_mfma_f32_32x32x16_bf16 v[80:95], v[20:23], v[112:115], v[80:95]
    s_setprio 0
    s_add_u32 m0, s55, 81920
    s_nop 0
    buffer_load_dwordx4 v3, s[20:23], s44 offen  lds
    s_lshl_b32 s5, s38, 16
    s_mul_i32 s4, s37, 2560
    s_add_u32 s65, s5, s4
    s_add_u32 s65, s65, 36864
    s_mov_b32 s12, 0x000fffff
    s_mov_b32 s13, 0x000fffff
    s_setprio 1
    s_waitcnt lgkmcnt(2)
    v_mfma_f32_32x32x16_bf16 v[64:79], v[24:27], v[116:119], v[64:79]
    ds_read_b64_tr_b16 v[16:17], v4 offset:45056
    ds_read_b64_tr_b16 v[18:19], v4 offset:45568
    ds_read_b64_tr_b16 v[20:21], v5 offset:45056
    ds_read_b64_tr_b16 v[22:23], v5 offset:45568
    s_waitcnt lgkmcnt(4)
    v_mfma_f32_32x32x16_bf16 v[80:95], v[28:31], v[116:119], v[80:95]
    s_setprio 0
    s_add_u32 m0, s55, 24576
    s_add_u32 s44, s44, 196608
    s_cmp_eq_u32 s44, 1966080
    s_cselect_b32 s44, 0, s44
    buffer_load_dwordx4 v2, s[16:19], s44 offen  lds
    s_lshl_b32 s4, s38, 8
    s_add_u32 s4, s4, 147456
    v_lshl_add_u32 v9, v0, 2, s4
    s_lshl_b32 s4, s37, 8
    s_add_u32 s4, s4, 150016
    v_and_b32 v6, 31, v0
    v_lshl_add_u32 v6, v6, 3, s4
    ds_read_b64_tr_b16 v[24:25], v4 offset:47104
    ds_read_b64_tr_b16 v[26:27], v4 offset:47616
    ds_read_b64_tr_b16 v[28:29], v5 offset:47104
    ds_read_b64_tr_b16 v[30:31], v5 offset:47616
    s_setprio 1
    s_waitcnt lgkmcnt(6)
    v_mfma_f32_32x32x16_bf16 v[64:79], v[16:19], v[120:123], v[64:79]
    s_add_u32 m0, s55, 90112
    s_nop 0
    buffer_load_dwordx4 v3, s[20:23], s44 offen  lds
    s_mov_b32 s14, -1
    s_mov_b32 s15, 0
    s_waitcnt lgkmcnt(4)
    v_mfma_f32_32x32x16_bf16 v[80:95], v[20:23], v[120:123], v[80:95]
    s_waitcnt lgkmcnt(0)
    s_waitcnt vmcnt(11)
    s_waitcnt vmcnt(3)
    s_barrier
    v_mfma_f32_32x32x16_bf16 v[64:79], v[24:27], v[124:127], v[64:79]
    ds_read_b64_tr_b16 v[16:17], v4 offset:49152
    ds_read_b64_tr_b16 v[18:19], v4 offset:49664
    ds_read_b64_tr_b16 v[20:21], v5 offset:49152
    ds_read_b64_tr_b16 v[22:23], v5 offset:49664
    v_mfma_f32_32x32x16_bf16 v[80:95], v[28:31], v[124:127], v[80:95]
    s_setprio 0
    s_add_u32 m0, s55, 32768
    s_add_u32 s44, s44, 196608
    s_cmp_eq_u32 s44, 1966080
    s_cselect_b32 s44, 0, s44
    buffer_load_dwordx4 v2, s[16:19], s44 offen  lds
    ds_read2st64_b32 v[12:13], v9 offset0:0 offset1:2
    ds_read2st64_b32 v[14:15], v9 offset0:4 offset1:6
    ds_read_b32 v8, v9 offset:2048
    ds_read_b64 v[6:7], v6
    s_setprio 1
    s_waitcnt lgkmcnt(6)
    v_mfma_f32_32x32x16_bf16 v[64:79], v[16:19], v[128:131], v[64:79]
    ds_read_b64_tr_b16 v[24:25], v4 offset:51200
    ds_read_b64_tr_b16 v[26:27], v4 offset:51712
    ds_read_b64_tr_b16 v[28:29], v5 offset:51200
    ds_read_b64_tr_b16 v[30:31], v5 offset:51712
    s_waitcnt lgkmcnt(8)
    v_mfma_f32_32x32x16_bf16 v[80:95], v[20:23], v[128:131], v[80:95]
    s_setprio 0
    s_add_u32 m0, s55, 98304
    s_nop 0
    buffer_load_dwordx4 v3, s[20:23], s44 offen  lds
    s_waitcnt lgkmcnt(7)
    v_add_f32 v12, v12, v13
    s_waitcnt lgkmcnt(6)
    v_add_f32 v14, v14, v15
    s_waitcnt lgkmcnt(5)
    v_add_f32 v12, v12, v8
    v_add_f32 v12, v12, v14
    v_cvt_pk_bf16_f32 v13, v12, v12
    v_lshlrev_b32 v13, 16, v13
    v_sub_f32 v13, v12, v13
    v_cvt_pk_bf16_f32 v14, v12, v13
    v_and_b32 v12, 0xffff0000, v14
    v_sub_f32 v13, v13, v12
    v_cvt_pk_bf16_f32 v15, v13, 0
    s_waitcnt lgkmcnt(4)
    v_cndmask_b32 v8, 0, v7, s[14:15]
    v_cndmask_b32 v12, v7, 0, s[14:15]
    v_and_b32 v9, 0xffff, v8
    v_and_b32 v13, 0xffff, v12
    s_nop 0
    v_mfma_f32_32x32x8_bf16 v[32:47], v[8:9], v[14:15], v[32:47]
    v_mfma_f32_32x32x8_bf16 v[48:63], v[12:13], v[14:15], v[48:63]
    s_lshl_b32 s4, s37, 8
    s_add_u32 s4, s4, 150016
    v_lshrrev_b32 v7, 5, v0
    v_lshl_add_u32 v7, v7, 5, s4
    s_setprio 1
    s_waitcnt lgkmcnt(2)
    v_mfma_f32_32x32x16_bf16 v[64:79], v[24:27], v[132:135], v[64:79]
    ds_read_b64_tr_b16 v[16:17], v4 offset:53248
    ds_read_b64_tr_b16 v[18:19], v4 offset:53760
    ds_read_b64_tr_b16 v[20:21], v5 offset:53248
    ds_read_b64_tr_b16 v[22:23], v5 offset:53760
    s_waitcnt lgkmcnt(4)
    v_mfma_f32_32x32x16_bf16 v[80:95], v[28:31], v[132:135], v[80:95]
    s_setprio 0
    s_add_u32 m0, s55, 40960
    s_add_u32 s44, s44, 196608
    s_cmp_eq_u32 s44, 1966080
    s_cselect_b32 s44, 0, s44
    buffer_load_dwordx4 v2, s[16:19], s44 offen  lds
    s_and_b32 s4, s40, 13
    s_lshl_b32 s4, s4, 1
    s_add_u32 s4, s4, s38
    s_cmp_eq_u32 s4, 26
    s_cselect_b32 s50, 1073741824, s75
    ds_read2_b32 v[12:13], v7 offset0:0 offset1:2
    ds_read2_b32 v[14:15], v7 offset0:4 offset1:6
    s_waitcnt lgkmcnt(1)
    v_mul_f32 v32, v12, v32
    v_mul_f32 v33, v13, v33
    s_waitcnt lgkmcnt(0)
    v_mul_f32 v34, v14, v34
    v_mul_f32 v35, v15, v35
    ds_read2_b32 v[12:13], v7 offset0:16 offset1:18
    ds_read2_b32 v[14:15], v7 offset0:20 offset1:22
    ds_read_b64_tr_b16 v[24:25], v4 offset:55296
    ds_read_b64_tr_b16 v[26:27], v4 offset:55808
    ds_read_b64_tr_b16 v[28:29], v5 offset:55296
    ds_read_b64_tr_b16 v[30:31], v5 offset:55808
    s_setprio 1
    v_mfma_f32_32x32x16_bf16 v[64:79], v[16:19], v[136:139], v[64:79]
    s_add_u32 m0, s55, 106496
    s_nop 0
    buffer_load_dwordx4 v3, s[20:23], s44 offen  lds
    s_waitcnt lgkmcnt(5)
    v_mul_f32 v36, v12, v36
    v_mul_f32 v37, v13, v37
    s_waitcnt lgkmcnt(4)
    v_mul_f32 v38, v14, v38
    v_mul_f32 v39, v15, v39
    ds_read2_b32 v[12:13], v7 offset0:32 offset1:34
    ds_read2_b32 v[14:15], v7 offset0:36 offset1:38
    v_cvt_pk_bf16_f32 v32, v32, v33
    v_mfma_f32_32x32x16_bf16 v[80:95], v[20:23], v[136:139], v[80:95]
    s_waitcnt lgkmcnt(0)
    s_waitcnt vmcnt(13)
    s_barrier
    v_mfma_f32_32x32x16_bf16 v[64:79], v[24:27], v[140:143], v[64:79]
    ds_read_b64_tr_b16 v[16:17], v4 offset:57344
    ds_read_b64_tr_b16 v[18:19], v4 offset:57856
    ds_read_b64_tr_b16 v[20:21], v5 offset:57344
    ds_read_b64_tr_b16 v[22:23], v5 offset:57856
    v_mfma_f32_32x32x16_bf16 v[80:95], v[28:31], v[140:143], v[80:95]
    s_setprio 0
    v_cvt_pk_bf16_f32 v33, v34, v35
    v_cvt_pk_bf16_f32 v34, v36, v37
    v_cvt_pk_bf16_f32 v35, v38, v39
    buffer_store_dwordx4 v[32:35], v10, s[24:27], s50 offen sc0 sc1
    v_mul_f32 v40, v12, v40
    v_mul_f32 v41, v13, v41
    v_mul_f32 v42, v14, v42
    v_mul_f32 v43, v15, v43
    ds_read2_b32 v[12:13], v7 offset0:48 offset1:50
    ds_read2_b32 v[14:15], v7 offset0:52 offset1:54
    s_waitcnt lgkmcnt(1)
    v_mul_f32 v44, v12, v44
    v_mul_f32 v45, v13, v45
    s_waitcnt lgkmcnt(0)
    v_mul_f32 v46, v14, v46
    v_mul_f32 v47, v15, v47
    v_cvt_pk_bf16_f32 v40, v40, v41
    v_cvt_pk_bf16_f32 v41, v42, v43
    v_cvt_pk_bf16_f32 v42, v44, v45
    v_cvt_pk_bf16_f32 v43, v46, v47
    s_setprio 1
    v_mfma_f32_32x32x16_bf16 v[64:79], v[16:19], v[144:147], v[64:79]
    ds_read_b64_tr_b16 v[24:25], v4 offset:59392
    ds_read_b64_tr_b16 v[26:27], v4 offset:59904
    ds_read_b64_tr_b16 v[28:29], v5 offset:59392
    ds_read_b64_tr_b16 v[30:31], v5 offset:59904
    v_mfma_f32_32x32x16_bf16 v[80:95], v[20:23], v[144:147], v[80:95]
    s_setprio 0
    buffer_store_dwordx4 v[40:43], v10, s[24:27], s50 offen offset:640 sc0 sc1
    v_mov_b32 v12, 163712
    v_mov_b32 v13, 82112
    v_cndmask_b32 v12, v12, v13, s[34:35]
    v_add_u32 v10, v10, v12
    s_and_b32 s4, s40, 13
    s_lshl_b32 s4, s4, 1
    s_add_u32 s4, s4, s38
    s_cmp_eq_u32 s4, 25
    s_cselect_b32 s50, 1073741824, s75
    ds_read2_b32 v[12:13], v7 offset0:0 offset1:2
    ds_read2_b32 v[14:15], v7 offset0:4 offset1:6
    s_waitcnt lgkmcnt(1)
    v_mul_f32 v48, v12, v48
    v_mul_f32 v49, v13, v49
    s_waitcnt lgkmcnt(0)
    v_mul_f32 v50, v14, v50
    v_mul_f32 v51, v15, v51
    ds_read2_b32 v[12:13], v7 offset0:16 offset1:18
    ds_read2_b32 v[14:15], v7 offset0:20 offset1:22
    s_setprio 1
    v_mfma_f32_32x32x16_bf16 v[64:79], v[24:27], v[148:151], v[64:79]
    ds_read_b64_tr_b16 v[16:17], v4 offset:61440
    ds_read_b64_tr_b16 v[18:19], v4 offset:61952
    ds_read_b64_tr_b16 v[20:21], v5 offset:61440
    ds_read_b64_tr_b16 v[22:23], v5 offset:61952
    v_mfma_f32_32x32x16_bf16 v[80:95], v[28:31], v[148:151], v[80:95]
    s_setprio 0
    s_waitcnt lgkmcnt(5)
    v_mul_f32 v52, v12, v52
    v_mul_f32 v53, v13, v53
    s_waitcnt lgkmcnt(4)
    v_mul_f32 v54, v14, v54
    v_mul_f32 v55, v15, v55
    ds_read2_b32 v[12:13], v7 offset0:32 offset1:34
    ds_read2_b32 v[14:15], v7 offset0:36 offset1:38
    v_cvt_pk_bf16_f32 v48, v48, v49
    v_cvt_pk_bf16_f32 v49, v50, v51
    v_cvt_pk_bf16_f32 v50, v52, v53
    v_cvt_pk_bf16_f32 v51, v54, v55
    buffer_store_dwordx4 v[48:51], v10, s[24:27], s50 offen sc0 sc1
    s_waitcnt lgkmcnt(1)
    v_mul_f32 v56, v12, v56
    v_mul_f32 v57, v13, v57
    s_waitcnt lgkmcnt(0)
    v_mul_f32 v58, v14, v58
    v_mul_f32 v59, v15, v59
    ds_read2_b32 v[12:13], v7 offset0:48 offset1:50
    ds_read2_b32 v[14:15], v7 offset0:52 offset1:54
    ds_read_b64_tr_b16 v[24:25], v4 offset:63488
    ds_read_b64_tr_b16 v[26:27], v4 offset:64000
    ds_read_b64_tr_b16 v[28:29], v5 offset:63488
    ds_read_b64_tr_b16 v[30:31], v5 offset:64000
    s_setprio 1
    v_mfma_f32_32x32x16_bf16 v[64:79], v[16:19], v[152:155], v[64:79]
    s_waitcnt lgkmcnt(5)
    v_mul_f32 v60, v12, v60
    v_mul_f32 v61, v13, v61
    s_waitcnt lgkmcnt(4)
    v_mul_f32 v62, v14, v62
    v_mul_f32 v63, v15, v63
    v_cvt_pk_bf16_f32 v56, v56, v57
    v_cvt_pk_bf16_f32 v57, v58, v59
    v_cvt_pk_bf16_f32 v58, v60, v61
    v_cvt_pk_bf16_f32 v59, v62, v63
    buffer_store_dwordx4 v[56:59], v10, s[24:27], s50 offen offset:640 sc0 sc1
    v_mfma_f32_32x32x16_bf16 v[80:95], v[20:23], v[152:155], v[80:95]
    s_waitcnt lgkmcnt(0)
    s_waitcnt vmcnt(15)
    s_barrier
    s_branch F_join
F_pj:
    s_setpc_b64 s[6:7]
F_join:
    v_mfma_f32_32x32x16_bf16 v[64:79], v[24:27], v[156:159], v[64:79]
    ds_read_b64_tr_b16 v[16:17], v4 offset:0
    ds_read_b64_tr_b16 v[18:19], v4 offset:512
    ds_read_b64_tr_b16 v[20:21], v5 offset:0
    ds_read_b64_tr_b16 v[22:23], v5 offset:512
    v_mfma_f32_32x32x16_bf16 v[80:95], v[28:31], v[156:159], v[80:95]
    s_setprio 0
    s_lshl_b32 s5, s37, 4
    v_lshrrev_b32 v3, 2, v0
    v_add_u32 v3, s5, v3
    v_and_b32 v38, 15, v0
    v_lshrrev_b32 v39, 5, v0
    v_lshl_add_u32 v38, v39, 4, v38
    v_bfe_u32 v39, v0, 4, 1
    s_setprio 1
    s_waitcnt lgkmcnt(2)
    v_mfma_f32_32x32x16_bf16 v[64:79], v[16:19], v[160:163], v[64:79]
    ds_read_b64_tr_b16 v[24:25], v4 offset:2048
    ds_read_b64_tr_b16 v[26:27], v4 offset:2560
    ds_read_b64_tr_b16 v[28:29], v5 offset:2048
    ds_read_b64_tr_b16 v[30:31], v5 offset:2560
    s_waitcnt lgkmcnt(4)
    v_mfma_f32_32x32x16_bf16 v[80:95], v[20:23], v[160:163], v[80:95]
    s_setprio 0
    v_mul_u32_u24 v3, 3072, v3
    v_mul_u32_u24 v39, 96, v39
    v_add_u32 v38, v38, v39
    s_and_b32 s4, s40, 1
    s_add_u32 s4, s4, s38
    s_lshl_b32 s4, s4, 7
    s_add_u32 s4, s4, 151552
    v_lshl_add_u32 v39, v38, 2, s4
    s_setprio 1
    s_waitcnt lgkmcnt(2)
    v_mfma_f32_32x32x16_bf16 v[64:79], v[24:27], v[164:167], v[64:79]
    ds_read_b64_tr_b16 v[16:17], v4 offset:4096
    ds_read_b64_tr_b16 v[18:19], v4 offset:4608
    ds_read_b64_tr_b16 v[20:21], v5 offset:4096
    ds_read_b64_tr_b16 v[22:23], v5 offset:4608
    s_waitcnt lgkmcnt(4)
    v_mfma_f32_32x32x16_bf16 v[80:95], v[28:31], v[164:167], v[80:95]
    s_setprio 0
    v_and_b32 v2, 3, v0
    v_lshl_add_u32 v2, v2, 4, v3
    v_and_b32 v43, 0x13, v0
    v_bfe_u32 v44, v0, 2, 1
    s_andn2_b32 s4, 1, s40
    s_lshl_b32 s4, s4, 2
    s_add_u32 s4, s4, s38
    s_lshl_b32 s4, s4, 6
    s_add_u32 s4, s4, 151552
    v_lshl_add_u32 v38, v38, 2, s4
    ds_read_b64_tr_b16 v[24:25], v4 offset:6144
    ds_read_b64_tr_b16 v[26:27], v4 offset:6656
    ds_read_b64_tr_b16 v[28:29], v5 offset:6144
    ds_read_b64_tr_b16 v[30:31], v5 offset:6656
    s_setprio 1
    s_waitcnt lgkmcnt(6)
    v_mfma_f32_32x32x16_bf16 v[64:79], v[16:19], v[168:171], v[64:79]
    v_lshl_add_u32 v43, v44, 3, v43
    ds_read2st64_b32 v[50:51], v39 offset0:0 offset1:3
    ds_read2st64_b32 v[52:53], v39 offset0:6 offset1:9
    s_waitcnt lgkmcnt(6)
    v_mfma_f32_32x32x16_bf16 v[80:95], v[20:23], v[168:171], v[80:95]
    s_waitcnt lgkmcnt(0)
    s_waitcnt vmcnt(13)
    s_barrier
    v_mfma_f32_32x32x16_bf16 v[64:79], v[24:27], v[172:175], v[64:79]
    ds_read_b64_tr_b16 v[16:17], v4 offset:8192
    ds_read_b64_tr_b16 v[18:19], v4 offset:8704
    ds_read_b64_tr_b16 v[20:21], v5 offset:8192
    ds_read_b64_tr_b16 v[22:23], v5 offset:8704
    v_mfma_f32_32x32x16_bf16 v[80:95], v[28:31], v[172:175], v[80:95]
    s_setprio 0
    v_add_u32 v2, s47, v2
    v_xor_b32 v3, 32, v2
    v_bfe_u32 v44, v0, 3, 1
    v_lshl_add_u32 v43, v44, 2, v43
    ds_read_b32 v54, v39 offset:3072
    ds_read2st64_b32 v[56:57], v38 offset0:0 offset1:3
    ds_read2st64_b32 v[58:59], v38 offset0:6 offset1:9
    s_setprio 1
    s_waitcnt lgkmcnt(5)
    v_mfma_f32_32x32x16_bf16 v[64:79], v[16:19], v[176:179], v[64:79]
    ds_read_b64_tr_b16 v[24:25], v4 offset:10240
    ds_read_b64_tr_b16 v[26:27], v4 offset:10752
    ds_read_b64_tr_b16 v[28:29], v5 offset:10240
    ds_read_b64_tr_b16 v[30:31], v5 offset:10752
    s_waitcnt lgkmcnt(7)
    v_mfma_f32_32x32x16_bf16 v[80:95], v[20:23], v[176:179], v[80:95]
    s_setprio 0
    s_add_u32 m0, s55, 49152
    s_mul_i32 s42, s38, 196608
    s_add_u32 s42, s42, 196608
    s_add_u32 s44, s44, s42
    s_sub_u32 s42, s44, 1966080
    s_cselect_b32 s44, s44, s42
    buffer_load_dwordx4 v2, s[16:19], s44 offen  lds
    ds_read_b32 v55, v38 offset:3072
    s_lshl_b32 s50, s57, 3
    s_lshl_b32 s5, s37, 1
    s_add_u32 s50, s50, s5
    s_add_u32 s50, s50, s38
    s_mul_i32 s50, s50, 136
    s_setprio 1
    s_waitcnt lgkmcnt(3)
    v_mfma_f32_32x32x16_bf16 v[64:79], v[24:27], v[180:183], v[64:79]
    ds_read_b64_tr_b16 v[16:17], v4 offset:12288
    ds_read_b64_tr_b16 v[18:19], v4 offset:12800
    ds_read_b64_tr_b16 v[20:21], v5 offset:12288
    ds_read_b64_tr_b16 v[22:23], v5 offset:12800
    s_waitcnt lgkmcnt(5)
    v_mfma_f32_32x32x16_bf16 v[80:95], v[28:31], v[180:183], v[80:95]
    s_setprio 0
    s_add_u32 m0, s55, 114688
    s_nop 0
    buffer_load_dwordx4 v3, s[20:23], s44 offen  lds
    v_lshlrev_b32 v43, 4, v43
    v_lshrrev_b32 v44, 5, v0
    ds_read_b64_tr_b16 v[24:25], v4 offset:14336
    ds_read_b64_tr_b16 v[26:27], v4 offset:14848
    ds_read_b64_tr_b16 v[28:29], v5 offset:14336
    ds_read_b64_tr_b16 v[30:31], v5 offset:14848
    s_setprio 1
    s_waitcnt lgkmcnt(6)
    v_mfma_f32_32x32x16_bf16 v[64:79], v[16:19], v[184:187], v[64:79]
    s_add_u32 m0, s55, 57344
    s_add_u32 s44, s44, 393216
    s_sub_u32 s42, s44, 1966080
    s_cselect_b32 s44, s44, s42
    buffer_load_dwordx4 v2, s[16:19], s44 offen  lds
    s_waitcnt lgkmcnt(4)
    v_mfma_f32_32x32x16_bf16 v[80:95], v[20:23], v[184:187], v[80:95]
    s_waitcnt lgkmcnt(0)
    s_waitcnt vmcnt(13)
    s_waitcnt vmcnt(3)
    s_barrier
    v_mfma_f32_32x32x16_bf16 v[64:79], v[24:27], v[188:191], v[64:79]
    ds_read_b64_tr_b16 v[16:17], v4 offset:16384
    ds_read_b64_tr_b16 v[18:19], v4 offset:16896
    ds_read_b64_tr_b16 v[20:21], v5 offset:16384
    ds_read_b64_tr_b16 v[22:23], v5 offset:16896
    v_mfma_f32_32x32x16_bf16 v[80:95], v[28:31], v[188:191], v[80:95]
    s_setprio 0
    s_add_u32 m0, s55, 122880
    s_nop 0
    buffer_load_dwordx4 v3, s[20:23], s44 offen  lds
    s_cmp_lg_u32 s36, 0
    s_cbranch_scc1 F_pub39
    s_lshl_b32 s4, s2, 5
    s_add_u32 s4, s4, 19678848
    s_add_u32 s5, s32, 3
    v_mov_b32 v24, s5
    v_mov_b32 v25, s33
    s_mov_b64 exec, 1
    buffer_store_dwordx2 v[24:25], off, s[24:27], s4 sc0 sc1
    s_mov_b64 exec, -1
F_pub39:
    s_setprio 1
    s_waitcnt lgkmcnt(2)
    v_mfma_f32_32x32x16_bf16 v[64:79], v[16:19], v[192:195], v[64:79]
    ds_read_b64_tr_b16 v[24:25], v4 offset:18432
    ds_read_b64_tr_b16 v[26:27], v4 offset:18944
    ds_read_b64_tr_b16 v[28:29], v5 offset:18432
    ds_read_b64_tr_b16 v[30:31], v5 offset:18944
    s_waitcnt lgkmcnt(4)
    v_mfma_f32_32x32x16_bf16 v[80:95], v[20:23], v[192:195], v[80:95]
    s_setprio 0
    v_lshrrev_b32 v63, 5, v0
    v_lshl_add_u32 v10, v44, 10, v43
    v_mul_u32_u24 v13, 320, v44
    v_mov_b32 v48, v8
    v_add_f32 v50, v50, v51
    s_setprio 1
    s_waitcnt lgkmcnt(2)
    v_mfma_f32_32x32x16_bf16 v[64:79], v[24:27], v[196:199], v[64:79]
    ds_read_b64_tr_b16 v[16:17], v4 offset:20480
    ds_read_b64_tr_b16 v[18:19], v4 offset:20992
    ds_read_b64_tr_b16 v[20:21], v5 offset:20480
    ds_read_b64_tr_b16 v[22:23], v5 offset:20992
    s_waitcnt lgkmcnt(4)
    v_mfma_f32_32x32x16_bf16 v[80:95], v[28:31], v[196:199], v[80:95]
    s_setprio 0
    v_bfe_u32 v62, v0, 2, 2
    v_and_b32 v44, 31, v0
    v_lshl_add_u32 v13, v44, 4, v13
    v_mov_b32 v49, 0
    v_add_f32 v52, v52, v53
    v_add_f32 v50, v50, v54
    v_add_f32 v50, v50, v52
    ds_read_b64_tr_b16 v[24:25], v4 offset:22528
    ds_read_b64_tr_b16 v[26:27], v4 offset:23040
    ds_read_b64_tr_b16 v[28:29], v5 offset:22528
    ds_read_b64_tr_b16 v[30:31], v5 offset:23040
    s_setprio 1
    s_waitcnt lgkmcnt(6)
    v_mfma_f32_32x32x16_bf16 v[64:79], v[16:19], v[200:203], v[64:79]
    v_lshl_add_u32 v63, v63, 3, v62
    v_add_f32 v56, v56, v57
    v_add_f32 v58, v58, v59
    s_waitcnt lgkmcnt(4)
    v_mfma_f32_32x32x16_bf16 v[80:95], v[20:23], v[200:203], v[80:95]
    s_waitcnt lgkmcnt(0)
    s_waitcnt vmcnt(12)
    s_barrier
    v_mfma_f32_32x32x16_bf16 v[64:79], v[24:27], v[204:207], v[64:79]
    s_branch F_pg5k
.p2align 12
F_pg5:
    s_setpc_b64 s[6:7]
F_pg5k:
    ds_read_b64_tr_b16 v[16:17], v4 offset:24576
    ds_read_b64_tr_b16 v[18:19], v4 offset:25088
    ds_read_b64_tr_b16 v[20:21], v5 offset:24576
    ds_read_b64_tr_b16 v[22:23], v5 offset:25088
    v_mfma_f32_32x32x16_bf16 v[80:95], v[28:31], v[204:207], v[80:95]
    s_setprio 0
    v_lshlrev_b32 v63, 6, v63
    s_lshl_b32 s4, s38, 16
    s_add_u32 s4, s4, 24576
    v_add_u32 v10, s4, v10
    s_add_u32 s4, s4, 12288
    v_add_u32 v13, s4, v13
    v_add_f32 v56, v56, v55
    v_add_f32 v56, v56, v58
    s_setprio 1
    s_waitcnt lgkmcnt(2)
    v_mfma_f32_32x32x16_bf16 v[64:79], v[16:19], v[208:211], v[64:79]
    ds_read_b64_tr_b16 v[24:25], v4 offset:26624
    ds_read_b64_tr_b16 v[26:27], v4 offset:27136
    ds_read_b64_tr_b16 v[28:29], v5 offset:26624
    ds_read_b64_tr_b16 v[30:31], v5 offset:27136
    s_waitcnt lgkmcnt(4)
    v_mfma_f32_32x32x16_bf16 v[80:95], v[20:23], v[208:211], v[80:95]
    s_setprio 0
    v_bfe_u32 v62, v0, 4, 1
    s_lshl_b32 s4, s38, 16
    s_lshl_b32 s5, s60, 3
    s_add_u32 s5, s5, s4
    s_add_u32 s5, s5, 26624
    v_add_u32 v12, s5, v43
    v_cvt_pk_bf16_f32 v51, v50, v50
    v_lshlrev_b32 v51, 16, v51
    v_sub_f32 v51, v50, v51
    s_setprio 1
    s_waitcnt lgkmcnt(2)
    v_mfma_f32_32x32x16_bf16 v[64:79], v[24:27], v[212:215], v[64:79]
    ds_read_b64_tr_b16 v[16:17], v4 offset:28672
    ds_read_b64_tr_b16 v[18:19], v4 offset:29184
    ds_read_b64_tr_b16 v[20:21], v5 offset:28672
    ds_read_b64_tr_b16 v[22:23], v5 offset:29184
    s_waitcnt lgkmcnt(4)
    v_mfma_f32_32x32x16_bf16 v[80:95], v[28:31], v[212:215], v[80:95]
    s_setprio 0
    v_lshl_add_u32 v63, v62, 16, v63
    v_mov_b32 v43, 149536
    v_mov_b32 v44, 149504
    s_mov_b32 s4, 0x11000000
    s_mov_b32 s5, s4
    v_cndmask_b32 v43, v43, v44, s[4:5]
    v_cvt_pk_bf16_f32 v52, v50, v51
    ds_read_b64_tr_b16 v[24:25], v4 offset:30720
    ds_read_b64_tr_b16 v[26:27], v4 offset:31232
    ds_read_b64_tr_b16 v[28:29], v5 offset:30720
    ds_read_b64_tr_b16 v[30:31], v5 offset:31232
    s_setprio 1
    s_waitcnt lgkmcnt(6)
    v_mfma_f32_32x32x16_bf16 v[64:79], v[16:19], v[216:219], v[64:79]
    s_add_u32 m0, s55, 0
    s_add_u32 s44, s44, 393216
    s_sub_u32 s42, s44, 1966080
    s_cselect_b32 s44, s44, s42
    buffer_load_dwordx4 v2, s[16:19], s44 offen  lds
    s_waitcnt lgkmcnt(4)
    v_mfma_f32_32x32x16_bf16 v[80:95], v[20:23], v[216:219], v[80:95]
    s_waitcnt lgkmcnt(0)
    s_waitcnt vmcnt(11)
    s_barrier
    v_mfma_f32_32x32x16_bf16 v[64:79], v[24:27], v[220:223], v[64:79]
    ds_read_b64_tr_b16 v[16:17], v4 offset:32768
    ds_read_b64_tr_b16 v[18:19], v4 offset:33280
    ds_read_b64_tr_b16 v[20:21], v5 offset:32768
    ds_read_b64_tr_b16 v[22:23], v5 offset:33280
    v_mfma_f32_32x32x16_bf16 v[80:95], v[28:31], v[220:223], v[80:95]
    s_setprio 0
    s_add_u32 m0, s55, 65536
    s_nop 0
    buffer_load_dwordx4 v3, s[20:23], s44 offen  lds
    v_permlane32_swap_b32 v49, v48
    v_mov_b32 v48, v49
    v_and_b32 v50, 0xffff0000, v52
    v_sub_f32 v51, v51, v50
    v_cvt_pk_bf16_f32 v53, v51, 0
    v_cvt_pk_bf16_f32 v57, v56, v56
    s_setprio 1
    s_waitcnt lgkmcnt(2)
    v_mfma_f32_32x32x16_bf16 v[64:79], v[16:19], v[224:227], v[64:79]
    ds_read_b64_tr_b16 v[24:25], v4 offset:34816
    ds_read_b64_tr_b16 v[26:27], v4 offset:35328
    ds_read_b64_tr_b16 v[28:29], v5 offset:34816
    ds_read_b64_tr_b16 v[30:31], v5 offset:35328
    s_waitcnt lgkmcnt(4)
    v_mfma_f32_32x32x16_bf16 v[80:95], v[20:23], v[224:227], v[80:95]
    s_setprio 0
    v_xor_b32 v62, s38, v62
    v_lshl_add_u32 v63, v62, 5, v63
    v_cndmask_b32 v13, v43, v13, s[12:13]
    v_mov_b32 v43, 149520
    v_lshlrev_b32 v57, 16, v57
    v_sub_f32 v57, v56, v57
    v_cvt_pk_bf16_f32 v58, v56, v57
    s_setprio 1
    s_waitcnt lgkmcnt(2)
    v_mfma_f32_32x32x16_bf16 v[64:79], v[24:27], v[228:231], v[64:79]
    ds_read_b64_tr_b16 v[16:17], v4 offset:36864
    ds_read_b64_tr_b16 v[18:19], v4 offset:37376
    ds_read_b64_tr_b16 v[20:21], v5 offset:36864
    ds_read_b64_tr_b16 v[22:23], v5 offset:37376
    s_waitcnt lgkmcnt(4)
    v_mfma_f32_32x32x16_bf16 v[80:95], v[28:31], v[228:231], v[80:95]
    s_setprio 0
    v_and_b32 v62, 3, v0
    v_cndmask_b32 v12, v43, v12, s[14:15]
    v_mov_b32 v14, 0xdddddddd
    v_and_b32 v49, 0xffff, v48
    v_and_b32 v56, 0xffff0000, v58
    v_sub_f32 v57, v57, v56
    s_add_u32 s5, s50, s56
    s_lshl_b32 s5, s5, 10
    s_add_u32 s49, s5, 7962624
    ds_read_b64_tr_b16 v[24:25], v4 offset:38912
    ds_read_b64_tr_b16 v[26:27], v4 offset:39424
    ds_read_b64_tr_b16 v[28:29], v5 offset:38912
    ds_read_b64_tr_b16 v[30:31], v5 offset:39424
    s_setprio 1
    s_waitcnt lgkmcnt(6)
    v_mfma_f32_32x32x16_bf16 v[64:79], v[16:19], v[232:235], v[64:79]
    s_add_u32 m0, s55, 8192
    s_add_u32 s44, s44, 393216
    s_sub_u32 s42, s44, 1966080
    s_cselect_b32 s44, s44, s42
    buffer_load_dwordx4 v2, s[16:19], s44 offen  lds
    s_waitcnt lgkmcnt(4)
    v_mfma_f32_32x32x16_bf16 v[80:95], v[20:23], v[232:235], v[80:95]
    s_waitcnt lgkmcnt(0)
    s_waitcnt vmcnt(11)
    s_barrier
    v_mfma_f32_32x32x16_bf16 v[64:79], v[24:27], v[236:239], v[64:79]
    ds_read_b64_tr_b16 v[16:17], v4 offset:40960
    ds_read_b64_tr_b16 v[18:19], v4 offset:41472
    ds_read_b64_tr_b16 v[20:21], v5 offset:40960
    ds_read_b64_tr_b16 v[22:23], v5 offset:41472
    v_mfma_f32_32x32x16_bf16 v[80:95], v[28:31], v[236:239], v[80:95]
    s_setprio 0
    s_add_u32 m0, s55, 73728
    s_nop 0
    buffer_load_dwordx4 v3, s[20:23], s44 offen  lds
    s_lshl_b32 s4, s57, 8
    s_lshl_b32 s5, s37, 6
    s_add_u32 s4, s4, s5
    s_lshl_b32 s5, s38, 5
    s_add_u32 s4, s4, s5
    v_and_b32 v60, 31, v0
    v_add_u32 v60, s4, v60
    v_cvt_pk_bf16_f32 v59, v57, 0
    s_setprio 1
    s_waitcnt lgkmcnt(2)
    v_mfma_f32_32x32x16_bf16 v[64:79], v[16:19], v[240:243], v[64:79]
    ds_read_b64_tr_b16 v[24:25], v4 offset:43008
    ds_read_b64_tr_b16 v[26:27], v4 offset:43520
    ds_read_b64_tr_b16 v[28:29], v5 offset:43008
    ds_read_b64_tr_b16 v[30:31], v5 offset:43520
    s_waitcnt lgkmcnt(4)
    v_mfma_f32_32x32x16_bf16 v[80:95], v[20:23], v[240:243], v[80:95]
    s_setprio 0
    v_lshl_add_u32 v63, v62, 3, v63
    v_mul_f32 v7, 0xbfb8aa3b, v6
    v_rcp_f32 v6, v6
    s_lshr_b32 s5, s56, 2
    s_add_u32 s50, s50, s5
    s_lshl_b32 s50, s50, 10
    s_bfe_u32 s5, s56, 0x10001
    s_lshl_b32 s5, s5, 9
    s_add_u32 s50, s50, s5
    s_setprio 1
    s_waitcnt lgkmcnt(2)
    v_mfma_f32_32x32x16_bf16 v[64:79], v[24:27], v[244:247], v[64:79]
    ds_read_b64_tr_b16 v[16:17], v4 offset:45056
    ds_read_b64_tr_b16 v[18:19], v4 offset:45568
    ds_read_b64_tr_b16 v[20:21], v5 offset:45056
    ds_read_b64_tr_b16 v[22:23], v5 offset:45568
    s_waitcnt lgkmcnt(4)
    v_mfma_f32_32x32x16_bf16 v[80:95], v[28:31], v[244:247], v[80:95]
    s_setprio 0
    v_lshlrev_b32 v60, 4, v60
    v_lshrrev_b32 v43, 5, v0
    v_lshl_add_u32 v61, v43, 30, v60
    v_lshl_add_u32 v60, v43, 15, v60
    s_lshl_b32 s5, s60, 3
    s_add_u32 s50, s50, s5
    s_add_u32 s50, s50, 7995392
    ds_read_b64_tr_b16 v[24:25], v4 offset:47104
    ds_read_b64_tr_b16 v[26:27], v4 offset:47616
    ds_read_b64_tr_b16 v[28:29], v5 offset:47104
    ds_read_b64_tr_b16 v[30:31], v5 offset:47616
    s_setprio 1
    s_waitcnt lgkmcnt(6)
    v_mfma_f32_32x32x16_bf16 v[64:79], v[16:19], v[248:251], v[64:79]
    s_add_u32 m0, s55, 16384
    s_add_u32 s44, s44, 393216
    s_sub_u32 s42, s44, 1966080
    s_cselect_b32 s44, s44, s42
    buffer_load_dwordx4 v2, s[16:19], s44 offen  lds
    s_waitcnt lgkmcnt(4)
    v_mfma_f32_32x32x16_bf16 v[80:95], v[20:23], v[248:251], v[80:95]
    s_waitcnt lgkmcnt(0)
    s_waitcnt vmcnt(7)
    s_barrier
    v_mfma_f32_32x32x16_bf16 v[64:79], v[24:27], v[252:255], v[64:79]
    ds_read_b64_tr_b16 v[16:17], v63 offset:49152
    ds_read_b64_tr_b16 v[18:19], v63 offset:49408
    ds_read_b64_tr_b16 v[20:21], v63 offset:50176
    ds_read_b64_tr_b16 v[22:23], v63 offset:50432
    v_mfma_f32_32x32x16_bf16 v[80:95], v[28:31], v[252:255], v[80:95]
    s_setprio 0
    s_add_u32 m0, s55, 81920
    s_nop 0
    buffer_load_dwordx4 v3, s[20:23], s44 offen  lds
    v_mfma_f32_32x32x8_bf16 v[32:47], v[58:59], v[8:9], 0
    s_waitcnt lgkmcnt(2)
    v_mfma_f32_32x32x16_bf16 v[32:47], v[16:19], v[96:99], v[32:47]
    ds_read_b64_tr_b16 v[24:25], v63 offset:51200
    ds_read_b64_tr_b16 v[26:27], v63 offset:51456
    v_mfma_f32_32x32x8_bf16 v[64:79], v[52:53], v[8:9], v[64:79]
    s_waitcnt lgkmcnt(2)
    v_mfma_f32_32x32x16_bf16 v[32:47], v[20:23], v[100:103], v[32:47]
    ds_read_b64_tr_b16 v[16:17], v63 offset:52224
    ds_read_b64_tr_b16 v[18:19], v63 offset:52480
    v_mfma_f32_32x32x8_bf16 v[80:95], v[52:53], v[48:49], v[80:95]
    buffer_load_dwordx2 v[54:55], v11, s[24:27], 0 offen sc1
    s_waitcnt lgkmcnt(2)
    v_mfma_f32_32x32x16_bf16 v[32:47], v[24:27], v[104:107], v[32:47]
    ds_read_b64_tr_b16 v[20:21], v63 offset:53248
    ds_read_b64_tr_b16 v[22:23], v63 offset:53504
    s_cmp_ge_u32 s36, 1
    s_cbranch_scc1 F_ifw40
    v_bfe_u32 v57, v0, 4, 1
    v_and_b32 v50, 15, v0
    v_mul_u32_u24 v50, 640, v50
    v_lshl_add_u32 v50, v57, 5, v50
    v_add_u32 v50, 149504, v50
    v_subrev_u32 v56, 1, v57
    v_and_b32 v56, 0x3f803f80, v56
    v_mov_b32 v57, v56
    v_mov_b32 v58, v56
    v_mov_b32 v59, v56
    ds_write_b128 v50, v[56:59]
F_ifw40:
    s_waitcnt lgkmcnt(2)
    v_mfma_f32_32x32x16_bf16 v[32:47], v[16:19], v[108:111], v[32:47]
    ds_read_b64_tr_b16 v[24:25], v63 offset:54272
    ds_read_b64_tr_b16 v[26:27], v63 offset:54528
    v_mul_f32 v64, v7, v64
    v_mul_f32 v65, v7, v65
    v_mul_f32 v66, v7, v66
    v_mul_f32 v67, v7, v67
    v_mul_f32 v68, v7, v68
    s_waitcnt lgkmcnt(2)
    v_mfma_f32_32x32x16_bf16 v[32:47], v[20:23], v[112:115], v[32:47]
    ds_read_b64_tr_b16 v[16:17], v63 offset:55296
    ds_read_b64_tr_b16 v[18:19], v63 offset:55552
    s_cmp_ge_u32 s36, 1
    s_cbranch_scc1 F_ifw41
    v_mov_b32 v56, 0x3f803f80
    v_mov_b32 v57, 0x3f80
    v_bfe_u32 v50, v0, 1, 2
    v_mul_u32_u24 v50, 3072, v50
    v_and_b32 v58, 1, v0
    v_lshl_add_u32 v50, v58, 9, v50
    v_add_u32 v50, 149520, v50
    ds_write_b64 v50, v[56:57]
    v_mov_b32 v50, 159744
    v_mov_b32 v58, 0
    v_mov_b32 v59, 0
    ds_write_b64 v50, v[58:59]
F_ifw41:
    s_waitcnt lgkmcnt(2)
    v_mfma_f32_32x32x16_bf16 v[32:47], v[24:27], v[116:119], v[32:47]
    ds_read_b64_tr_b16 v[20:21], v63 offset:56320
    ds_read_b64_tr_b16 v[22:23], v63 offset:56576
    s_add_u32 s4, s32, 3
    s_waitcnt vmcnt(0)
    v_xor_b32 v55, s33, v55
    v_subrev_u32 v54, s4, v54
    v_lshrrev_b32 v54, 3, v54
    v_or_b32 v55, v55, v54
    v_cmp_ne_u32 vcc, 0, v55
    s_nop 4
    s_cbranch_vccnz F_spin38
F_ok37:
    s_waitcnt lgkmcnt(2)
    v_mfma_f32_32x32x16_bf16 v[32:47], v[16:19], v[120:123], v[32:47]
    s_waitcnt vmcnt(7)
    s_barrier
    ds_read_b64_tr_b16 v[24:25], v63 offset:57344
    ds_read_b64_tr_b16 v[26:27], v63 offset:57600
    s_lshl_b32 s4, s58, 15
    buffer_load_dwordx4 v[108:111], v60, s[24:27], s4 offen sc1
    v_xor_b32 v60, 512, v60
    buffer_load_dwordx4 v[112:115], v60, s[24:27], s4 offen sc1
    v_mul_f32 v69, v7, v69
    s_waitcnt lgkmcnt(2)
    v_mfma_f32_32x32x16_bf16 v[32:47], v[20:23], v[124:127], v[32:47]
    ds_read_b64_tr_b16 v[16:17], v63 offset:58368
    ds_read_b64_tr_b16 v[18:19], v63 offset:58624
    v_mul_f32 v70, v7, v70
    v_mul_f32 v71, v7, v71
    v_exp_f32 v64, v64
    v_exp_f32 v65, v65
    s_waitcnt lgkmcnt(2)
    v_mfma_f32_32x32x16_bf16 v[32:47], v[24:27], v[128:131], v[32:47]
    ds_read_b64_tr_b16 v[20:21], v63 offset:59392
    ds_read_b64_tr_b16 v[22:23], v63 offset:59648
    s_add_u32 m0, s64, s67
    s_nop 0
    buffer_load_dwordx4 v1, s[24:27], s62 offen sc1 lds
    v_exp_f32 v66, v66
    s_waitcnt lgkmcnt(2)
    v_mfma_f32_32x32x16_bf16 v[32:47], v[16:19], v[132:135], v[32:47]
    ds_read_b64_tr_b16 v[24:25], v63 offset:60416
    ds_read_b64_tr_b16 v[26:27], v63 offset:60672
    v_exp_f32 v67, v67
    v_exp_f32 v68, v68
    s_waitcnt lgkmcnt(2)
    v_mfma_f32_32x32x16_bf16 v[32:47], v[20:23], v[136:139], v[32:47]
    ds_read_b64_tr_b16 v[16:17], v63 offset:61440
    ds_read_b64_tr_b16 v[18:19], v63 offset:61696
    s_add_u32 m0, m0, 1024
    s_add_u32 s4, s62, 32768
    buffer_load_dwordx4 v1, s[24:27], s4 offen sc1 lds
    v_exp_f32 v69, v69
    v_exp_f32 v70, v70
    s_waitcnt lgkmcnt(2)
    v_mfma_f32_32x32x16_bf16 v[32:47], v[24:27], v[140:143], v[32:47]
    ds_read_b64_tr_b16 v[20:21], v63 offset:62464
    ds_read_b64_tr_b16 v[22:23], v63 offset:62720
    v_exp_f32 v71, v71
    v_fma_f32 v64, v64, v6, v6
    v_fma_f32 v65, v65, v6, v6
    s_waitcnt lgkmcnt(2)
    v_mfma_f32_32x32x16_bf16 v[32:47], v[16:19], v[144:147], v[32:47]
    ds_read_b64_tr_b16 v[24:25], v63 offset:63488
    ds_read_b64_tr_b16 v[26:27], v63 offset:63744
    v_fma_f32 v66, v66, v6, v6
    v_fma_f32 v67, v67, v6, v6
    v_fma_f32 v68, v68, v6, v6
    v_fma_f32 v69, v69, v6, v6
    v_fma_f32 v70, v70, v6, v6
    s_waitcnt lgkmcnt(2)
    v_mfma_f32_32x32x16_bf16 v[32:47], v[20:23], v[148:151], v[32:47]
    ds_read_b64_tr_b16 v[16:17], v63 offset:64512
    ds_read_b64_tr_b16 v[18:19], v63 offset:64768
    s_add_u32 m0, m0, 1024
    s_add_u32 s4, s62, s61
    buffer_load_dwordx4 v1, s[24:27], s4 offen sc1 lds
    v_fma_f32 v71, v71, v6, v6
    v_rcp_f32 v64, v64
    s_waitcnt lgkmcnt(2)
    v_mfma_f32_32x32x16_bf16 v[32:47], v[24:27], v[152:155], v[32:47]
    s_waitcnt vmcnt(10)
    s_barrier
    ds_read_b64_tr_b16 v[20:21], v63 offset:0
    ds_read_b64_tr_b16 v[22:23], v63 offset:256
    v_rcp_f32 v65, v65
    v_rcp_f32 v66, v66
    s_waitcnt lgkmcnt(2)
    v_mfma_f32_32x32x16_bf16 v[32:47], v[16:19], v[156:159], v[32:47]
    ds_read_b64_tr_b16 v[24:25], v63 offset:1024
    ds_read_b64_tr_b16 v[26:27], v63 offset:1280
    s_add_u32 m0, s65, s67
    s_add_u32 s62, s62, 4096
    buffer_load_dwordx4 v1, s[24:27], s63 offen sc1 lds
    v_rcp_f32 v67, v67
    v_rcp_f32 v68, v68
    s_waitcnt lgkmcnt(2)
    v_mfma_f32_32x32x16_bf16 v[32:47], v[20:23], v[160:163], v[32:47]
    ds_read_b64_tr_b16 v[16:17], v63 offset:2048
    ds_read_b64_tr_b16 v[18:19], v63 offset:2304
    v_rcp_f32 v69, v69
    v_rcp_f32 v70, v70
    s_waitcnt lgkmcnt(2)
    v_mfma_f32_32x32x16_bf16 v[32:47], v[24:27], v[164:167], v[32:47]
    ds_read_b64_tr_b16 v[20:21], v63 offset:3072
    ds_read_b64_tr_b16 v[22:23], v63 offset:3328
    buffer_load_dwordx4 v1, s[24:27], s63 offen offset:1024 sc1 lds
    v_rcp_f32 v71, v71
    v_mul_f32 v64, v64, v72
    v_mul_f32 v65, v65, v73
    s_waitcnt lgkmcnt(2)
    v_mfma_f32_32x32x16_bf16 v[32:47], v[16:19], v[168:171], v[32:47]
    ds_read_b64_tr_b16 v[24:25], v63 offset:4096
    ds_read_b64_tr_b16 v[26:27], v63 offset:4352
    v_mul_f32 v66, v66, v74
    v_mul_f32 v67, v67, v75
    v_mul_f32 v68, v68, v76
    v_mul_f32 v69, v69, v77
    v_mul_f32 v70, v70, v78
    s_waitcnt lgkmcnt(2)
    v_mfma_f32_32x32x16_bf16 v[32:47], v[20:23], v[172:175], v[32:47]
    ds_read_b64_tr_b16 v[16:17], v63 offset:5120
    ds_read_b64_tr_b16 v[18:19], v63 offset:5376
    v_mul_f32 v71, v71, v79
    v_cvt_pk_bf16_f32 v64, v64, v65
    v_cvt_pk_bf16_f32 v65, v66, v67
    v_cvt_pk_bf16_f32 v66, v68, v69
    v_cvt_pk_bf16_f32 v67, v70, v71
    s_waitcnt lgkmcnt(2)
    v_mfma_f32_32x32x16_bf16 v[32:47], v[24:27], v[176:179], v[32:47]
    ds_read_b64_tr_b16 v[20:21], v63 offset:6144
    ds_read_b64_tr_b16 v[22:23], v63 offset:6400
    buffer_load_dwordx4 v1, s[24:27], s63 offen offset:2048 sc1 lds
    v_mul_f32 v80, v7, v80
    v_mul_f32 v81, v7, v81
    v_mul_f32 v82, v7, v82
    s_waitcnt lgkmcnt(2)
    v_mfma_f32_32x32x16_bf16 v[32:47], v[16:19], v[180:183], v[32:47]
    ds_read_b64_tr_b16 v[24:25], v63 offset:7168
    ds_read_b64_tr_b16 v[26:27], v63 offset:7424
    v_and_b32 v50, 0x798, v4
    v_lshrrev_b32 v51, 11, v4
    v_mul_f32 v83, v7, v83
    v_mul_f32 v84, v7, v84
    v_mul_f32 v85, v7, v85
    s_waitcnt lgkmcnt(2)
    v_mfma_f32_32x32x16_bf16 v[32:47], v[20:23], v[184:187], v[32:47]
    s_waitcnt vmcnt(11)
    s_barrier
    ds_read_b64_tr_b16 v[16:17], v63 offset:8192
    ds_read_b64_tr_b16 v[18:19], v63 offset:8448
    s_add_u32 s63, s63, 10240
    v_mul_f32 v86, v7, v86
    v_mul_f32 v87, v7, v87
    v_exp_f32 v80, v80
    s_waitcnt lgkmcnt(2)
    v_mfma_f32_32x32x16_bf16 v[32:47], v[24:27], v[188:191], v[32:47]
    ds_read_b64_tr_b16 v[20:21], v63 offset:9216
    ds_read_b64_tr_b16 v[22:23], v63 offset:9472
    s_add_u32 s4, s45, 131072
    v_add3_u32 v50, v50, v51, s4
    v_exp_f32 v81, v81
    s_waitcnt lgkmcnt(2)
    v_mfma_f32_32x32x16_bf16 v[32:47], v[16:19], v[192:195], v[32:47]
    ds_read_b64_tr_b16 v[24:25], v63 offset:10240
    ds_read_b64_tr_b16 v[26:27], v63 offset:10496
    s_lshl_b32 s4, s59, 15
    s_lshl_b32 s5, s60, 3
    s_add_u32 s4, s4, s5
    buffer_load_dwordx2 v[116:117], v61, s[24:27], s4 offen sc1
    v_xor_b32 v61, 512, v61
    buffer_load_dwordx2 v[118:119], v61, s[24:27], s4 offen sc1
    s_waitcnt vmcnt(43)
    ds_read_b64_tr_b16 v[52:53], v50 offset:0
    ds_read_b64_tr_b16 v[54:55], v50 offset:512
    ds_read_b64_tr_b16 v[56:57], v50 offset:64
    ds_read_b64_tr_b16 v[58:59], v50 offset:576
    s_waitcnt lgkmcnt(6)
    v_mfma_f32_32x32x16_bf16 v[32:47], v[20:23], v[196:199], v[32:47]
    ds_read_b64_tr_b16 v[16:17], v63 offset:11264
    ds_read_b64_tr_b16 v[18:19], v63 offset:11520
    v_mov_b32 v2, -1
    v_exp_f32 v82, v82
    v_exp_f32 v83, v83
    s_waitcnt lgkmcnt(6)
    v_mfma_f32_32x32x16_bf16 v[32:47], v[24:27], v[200:203], v[32:47]
    ds_read_b64_tr_b16 v[20:21], v63 offset:12288
    ds_read_b64_tr_b16 v[22:23], v63 offset:12544
    v_mov_b32 v3, -1
    v_exp_f32 v84, v84
    v_exp_f32 v85, v85
    s_waitcnt lgkmcnt(2)
    v_mfma_f32_32x32x16_bf16 v[32:47], v[16:19], v[204:207], v[32:47]
    ds_read_b64_tr_b16 v[24:25], v63 offset:13312
    ds_read_b64_tr_b16 v[26:27], v63 offset:13568
    v_exp_f32 v86, v86
    v_exp_f32 v87, v87
    s_waitcnt lgkmcnt(2)
    v_mfma_f32_32x32x16_bf16 v[32:47], v[20:23], v[208:211], v[32:47]
    ds_read_b64_tr_b16 v[16:17], v63 offset:14336
    ds_read_b64_tr_b16 v[18:19], v63 offset:14592
    buffer_store_dwordx4 v[64:67], v1, s[24:27], s51 offen sc0 sc1
    v_fma_f32 v80, v80, v6, v6
    v_fma_f32 v81, v81, v6, v6
    v_fma_f32 v82, v82, v6, v6
    v_fma_f32 v83, v83, v6, v6
    s_waitcnt lgkmcnt(2)
    v_mfma_f32_32x32x16_bf16 v[32:47], v[24:27], v[212:215], v[32:47]
    ds_read_b64_tr_b16 v[20:21], v63 offset:15360
    ds_read_b64_tr_b16 v[22:23], v63 offset:15616
    v_mov_b32 v4, -1
    v_fma_f32 v84, v84, v6, v6
    v_fma_f32 v85, v85, v6, v6
    v_fma_f32 v86, v86, v6, v6
    s_waitcnt lgkmcnt(2)
    v_mfma_f32_32x32x16_bf16 v[32:47], v[16:19], v[216:219], v[32:47]
    s_waitcnt vmcnt(12)
    s_barrier
    ds_read_b64_tr_b16 v[24:25], v63 offset:16384
    ds_read_b64_tr_b16 v[26:27], v63 offset:16640
    buffer_store_dwordx4 v[52:55], v1, s[24:27], s74 offen sc0 sc1
    v_fma_f32 v87, v87, v6, v6
    v_rcp_f32 v80, v80
    s_waitcnt lgkmcnt(2)
    v_mfma_f32_32x32x16_bf16 v[32:47], v[20:23], v[220:223], v[32:47]
    ds_read_b64_tr_b16 v[16:17], v63 offset:17408
    ds_read_b64_tr_b16 v[18:19], v63 offset:17664
    s_add_u32 s5, s74, 139264
    buffer_store_dwordx4 v[56:59], v1, s[24:27], s5 offen sc0 sc1
    v_rcp_f32 v81, v81
    v_rcp_f32 v82, v82
    s_waitcnt lgkmcnt(2)
    v_mfma_f32_32x32x16_bf16 v[32:47], v[24:27], v[224:227], v[32:47]
    ds_read_b64_tr_b16 v[20:21], v63 offset:18432
    ds_read_b64_tr_b16 v[22:23], v63 offset:18688
    v_mov_b32 v5, -1
    v_rcp_f32 v83, v83
    s_waitcnt lgkmcnt(2)
    v_mfma_f32_32x32x16_bf16 v[32:47], v[16:19], v[228:231], v[32:47]
    ds_read_b64_tr_b16 v[24:25], v63 offset:19456
    ds_read_b64_tr_b16 v[26:27], v63 offset:19712
    buffer_store_dwordx4 v[2:5], v1, s[24:27], s49 offen sc0 sc1
    v_rcp_f32 v84, v84
    v_rcp_f32 v85, v85
    s_waitcnt lgkmcnt(2)
    v_mfma_f32_32x32x16_bf16 v[32:47], v[20:23], v[232:235], v[32:47]
    ds_read_b64_tr_b16 v[16:17], v63 offset:20480
    ds_read_b64_tr_b16 v[18:19], v63 offset:20736
    v_rcp_f32 v86, v86
    v_rcp_f32 v87, v87
    v_mul_f32 v80, v80, v88
    s_waitcnt lgkmcnt(2)
    v_mfma_f32_32x32x16_bf16 v[32:47], v[24:27], v[236:239], v[32:47]
    ds_read_b64_tr_b16 v[20:21], v63 offset:21504
    ds_read_b64_tr_b16 v[22:23], v63 offset:21760
    s_mov_b64 exec, s[14:15]
    buffer_store_dwordx2 v[2:3], v1, s[24:27], s50 offen sc0 sc1
    s_mov_b64 exec, -1
    v_mul_f32 v81, v81, v89
    v_mul_f32 v82, v82, v90
    s_waitcnt lgkmcnt(2)
    v_mfma_f32_32x32x16_bf16 v[32:47], v[16:19], v[240:243], v[32:47]
    ds_read_b64_tr_b16 v[24:25], v63 offset:22528
    ds_read_b64_tr_b16 v[26:27], v63 offset:22784
    v_mul_f32 v83, v83, v91
    v_mul_f32 v84, v84, v92
    v_mul_f32 v85, v85, v93
    v_mul_f32 v86, v86, v94
    v_mul_f32 v87, v87, v95
    s_waitcnt lgkmcnt(2)
    v_mfma_f32_32x32x16_bf16 v[32:47], v[20:23], v[244:247], v[32:47]
    ds_read_b64_tr_b16 v[16:17], v63 offset:23552
    ds_read_b64_tr_b16 v[18:19], v63 offset:23808
    v_cvt_pk_bf16_f32 v80, v80, v81
    v_cvt_pk_bf16_f32 v81, v82, v83
    v_cvt_pk_bf16_f32 v82, v84, v85
    v_cvt_pk_bf16_f32 v83, v86, v87
    s_waitcnt lgkmcnt(2)
    v_mfma_f32_32x32x16_bf16 v[32:47], v[24:27], v[248:251], v[32:47]
    buffer_store_dwordx4 v[80:83], v1, s[24:27], s51 offen offset:1024 sc0 sc1
    s_waitcnt lgkmcnt(0)
    v_mfma_f32_32x32x16_bf16 v[32:47], v[16:19], v[252:255], v[32:47]
    s_lshl_b32 s4, s38, 16
    v_subrev_u32 v104, s4, v10
    v_subrev_u32 v105, s4, v12
    v_cndmask_b32 v105, v12, v105, s[14:15]
    s_cmp_ge_u32 s36, 4
    s_cbranch_scc1 F_g1
    s_nop 15
    s_nop 3
    v_pk_mul_f32 v[32:33], v[32:33], v[6:7] op_sel:[0,1] op_sel_hi:[1,1]
    v_pk_mul_f32 v[34:35], v[34:35], v[6:7] op_sel:[0,1] op_sel_hi:[1,1]
    v_pk_mul_f32 v[36:37], v[36:37], v[6:7] op_sel:[0,1] op_sel_hi:[1,1]
    v_pk_mul_f32 v[38:39], v[38:39], v[6:7] op_sel:[0,1] op_sel_hi:[1,1]
    v_exp_f32 v32, v32
    v_exp_f32 v33, v33
    v_exp_f32 v34, v34
    v_exp_f32 v35, v35
    v_exp_f32 v36, v36
    v_exp_f32 v37, v37
    v_exp_f32 v38, v38
    v_exp_f32 v39, v39
    v_pk_fma_f32 v[32:33], v[32:33], v[6:7], v[6:7] op_sel_hi:[1,0,0]
    v_pk_fma_f32 v[34:35], v[34:35], v[6:7], v[6:7] op_sel_hi:[1,0,0]
    v_pk_fma_f32 v[36:37], v[36:37], v[6:7], v[6:7] op_sel_hi:[1,0,0]
    v_pk_fma_f32 v[38:39], v[38:39], v[6:7], v[6:7] op_sel_hi:[1,0,0]
    v_rcp_f32 v32, v32
    v_rcp_f32 v33, v33
    v_rcp_f32 v34, v34
    v_rcp_f32 v35, v35
    v_rcp_f32 v36, v36
    v_rcp_f32 v37, v37
    v_rcp_f32 v38, v38
    v_rcp_f32 v39, v39
    v_pk_mul_f32 v[32:33], v[32:33], v[40:41]
    v_pk_mul_f32 v[34:35], v[34:35], v[42:43]
    v_pk_mul_f32 v[36:37], v[36:37], v[44:45]
    v_pk_mul_f32 v[38:39], v[38:39], v[46:47]
    v_cvt_pk_bf16_f32 v32, v32, v33
    v_cvt_pk_bf16_f32 v33, v34, v35
    v_cvt_pk_bf16_f32 v34, v36, v37
    v_cvt_pk_bf16_f32 v35, v38, v39
F_g1:
    s_waitcnt lgkmcnt(0)
    s_waitcnt vmcnt(6)
    s_barrier
    s_setprio 3
    ds_read_b128 v[124:127], v104 offset:0
    ds_read_b64 v[130:131], v105 offset:0
    ds_read_b128 v[120:123], v10 offset:0
    ds_read_b64 v[128:129], v12 offset:0
    ds_read_b128 v[132:135], v13 offset:0
    ds_read_b128 v[136:139], v13 offset:640
    s_cmp_lt_u32 s36, 4
    s_cbranch_scc1 F_g2
    v_pk_mul_f32 v[32:33], v[32:33], v[6:7] op_sel:[0,1] op_sel_hi:[1,1]
    v_pk_mul_f32 v[34:35], v[34:35], v[6:7] op_sel:[0,1] op_sel_hi:[1,1]
    v_pk_mul_f32 v[36:37], v[36:37], v[6:7] op_sel:[0,1] op_sel_hi:[1,1]
    v_pk_mul_f32 v[38:39], v[38:39], v[6:7] op_sel:[0,1] op_sel_hi:[1,1]
    v_exp_f32 v32, v32
    v_exp_f32 v33, v33
    v_exp_f32 v34, v34
    v_exp_f32 v35, v35
    v_exp_f32 v36, v36
    v_exp_f32 v37, v37
    v_exp_f32 v38, v38
    v_exp_f32 v39, v39
    v_pk_fma_f32 v[32:33], v[32:33], v[6:7], v[6:7] op_sel_hi:[1,0,0]
    v_pk_fma_f32 v[34:35], v[34:35], v[6:7], v[6:7] op_sel_hi:[1,0,0]
    v_pk_fma_f32 v[36:37], v[36:37], v[6:7], v[6:7] op_sel_hi:[1,0,0]
    v_pk_fma_f32 v[38:39], v[38:39], v[6:7], v[6:7] op_sel_hi:[1,0,0]
    v_rcp_f32 v32, v32
    v_rcp_f32 v33, v33
    v_rcp_f32 v34, v34
    v_rcp_f32 v35, v35
    v_rcp_f32 v36, v36
    v_rcp_f32 v37, v37
    v_rcp_f32 v38, v38
    v_rcp_f32 v39, v39
    v_pk_mul_f32 v[32:33], v[32:33], v[40:41]
    v_pk_mul_f32 v[34:35], v[34:35], v[42:43]
    v_pk_mul_f32 v[36:37], v[36:37], v[44:45]
    v_pk_mul_f32 v[38:39], v[38:39], v[46:47]
    v_cvt_pk_bf16_f32 v32, v32, v33
    v_cvt_pk_bf16_f32 v33, v34, v35
    v_cvt_pk_bf16_f32 v34, v36, v37
    v_cvt_pk_bf16_f32 v35, v38, v39
F_g2:
    s_waitcnt lgkmcnt(4)
    v_mfma_f32_32x32x8_bf16 v[148:163], v[130:131], v[116:117], 0
    v_mfma_f32_32x32x16_bf16 v[148:163], v[124:127], v[108:111], v[148:163]
    v_mfma_f32_32x32x8_bf16 v[164:179], v[130:131], v[118:119], 0
    v_mfma_f32_32x32x16_bf16 v[164:179], v[124:127], v[112:115], v[164:179]
    s_branch F_pg6k
.p2align 12
F_pg6:
    s_setpc_b64 s[6:7]
F_pg6k:
    buffer_store_dwordx4 v[32:35], v1, s[24:27], s52 offen sc0 sc1
    s_nop 8
    v_max3_f32 v103, v148, v149, v150
    s_nop 0
    v_max3_f32 v106, v164, v165, v166
    v_max3_f32 v103, v103, v151, v152
    v_max3_f32 v106, v106, v167, v168
    v_max3_f32 v103, v103, v153, v154
    v_max3_f32 v106, v106, v169, v170
    v_max3_f32 v103, v103, v155, v156
    v_max3_f32 v106, v106, v171, v172
    v_max3_f32 v103, v103, v157, v158
    v_max3_f32 v106, v106, v173, v174
    v_max3_f32 v103, v103, v159, v160
    v_max3_f32 v106, v106, v175, v176
    v_max3_f32 v103, v103, v161, v162
    v_max3_f32 v106, v106, v177, v178
    v_max3_f32 v103, v103, v163, v163
    v_max3_f32 v106, v106, v179, v179
    v_mov_b32 v100, v103
    v_mov_b32 v104, v106
    s_nop 0
    v_permlane32_swap_b32 v100, v103
    v_permlane32_swap_b32 v104, v106
    v_max_f32 v103, v100, v103
    v_max_f32 v106, v104, v106
    v_sub_f32 v103, 0, v103
    v_sub_f32 v106, 0, v106
    v_cvt_pk_bf16_f32 v102, v103, v103
    v_cvt_pk_bf16_f32 v107, v106, v106
    v_lshlrev_b32 v102, 16, v102
    v_lshlrev_b32 v107, 16, v107
    v_sub_f32 v102, v103, v102
    v_sub_f32 v107, v106, v107
    v_cvt_pk_bf16_f32 v100, v103, v102
    v_cvt_pk_bf16_f32 v104, v106, v107
    v_and_b32 v103, 0xffff0000, v100
    v_and_b32 v106, 0xffff0000, v104
    v_sub_f32 v102, v102, v103
    v_sub_f32 v107, v107, v106
    v_cvt_pk_bf16_f32 v101, v102, 0
    v_cvt_pk_bf16_f32 v105, v107, 0
    v_cndmask_b32 v116, v100, v116, s[14:15]
    v_cndmask_b32 v118, v104, v118, s[14:15]
    v_cndmask_b32 v117, v101, v117, s[14:15]
    v_cndmask_b32 v119, v105, v119, s[14:15]
F_retry:
    v_mov_b32 v216, 0
    v_mov_b32 v217, 0
    s_waitcnt lgkmcnt(2)
    v_mfma_f32_32x32x8_bf16 v[148:163], v[128:129], v[116:117], 0
    v_mfma_f32_32x32x16_bf16 v[148:163], v[120:123], v[108:111], v[148:163]
    s_mov_b32 s66, 2
    s_mov_b32 s67, -23552
    s_mov_b32 s68, -23552
    s_waitcnt lgkmcnt(0)
    s_nop 7
    v_exp_f32 v148, v148
    v_exp_f32 v149, v149
    v_mfma_f32_32x32x8_bf16 v[180:195], v[216:217], v[216:217], 0
    s_and_b32 s4, s2, 7
    s_lshr_b32 s5, s2, 3
    s_lshr_b32 s23, s4, 1
    s_lshl_b32 s23, s23, 4
    s_and_b32 s6, s5, 15
    s_add_u32 s23, s23, s6
    s_and_b32 s100, s4, 1
    s_lshl_b32 s100, s100, 1
    s_lshr_b32 s5, s5, 4
    s_add_u32 s100, s100, s5
    v_exp_f32 v150, v150
    v_exp_f32 v151, v151
    v_mfma_f32_32x32x8_bf16 v[164:179], v[128:129], v[118:119], 0
    v_exp_f32 v152, v152
    v_exp_f32 v153, v153
    v_exp_f32 v154, v154
    v_mfma_f32_32x32x16_bf16 v[164:179], v[120:123], v[112:115], v[164:179]
    s_waitcnt lgkmcnt(0)
    ds_read_b128 v[124:127], v10 offset:512
    ds_read_b64 v[130:131], v12 offset:512
    v_exp_f32 v155, v155
    v_exp_f32 v156, v156
    v_exp_f32 v157, v157
    v_exp_f32 v158, v158
    v_smfmac_f32_32x32x32_bf16 v[180:195], v[132:135], v[148:155], v14
    v_exp_f32 v159, v159
    v_exp_f32 v160, v160
    v_exp_f32 v161, v161
    v_mfma_f32_32x32x8_bf16 v[196:211], v[216:217], v[216:217], 0
    v_exp_f32 v162, v162
    v_exp_f32 v163, v163
    s_setprio 2
    v_exp_f32 v164, v164
    v_exp_f32 v165, v165
    v_smfmac_f32_32x32x32_bf16 v[180:195], v[136:139], v[156:163], v14
    s_waitcnt lgkmcnt(0)
    s_mul_i32 s4, s36, 12
    s_mul_i32 s5, s23, 136
    s_add_u32 s16, s5, s4
    s_lshl_b32 s16, s16, 10
    s_add_u32 s16, s16, 7864320
    s_mul_i32 s6, s100, 680
    s_add_u32 s17, s6, s4
    s_lshl_b32 s17, s17, 10
    s_add_u32 s17, s17, 16777216
    s_mul_i32 s4, s36, 5
    s_add_u32 s5, s5, s4
    s_lshl_b32 s5, s5, 10
    s_add_u32 s53, s5, 7962624
    s_add_u32 s6, s6, s4
    s_lshl_b32 s6, s6, 10
    s_add_u32 s42, s6, 16875520
    v_exp_f32 v166, v166
    v_exp_f32 v167, v167
    v_mfma_f32_32x32x8_bf16 v[148:163], v[130:131], v[116:117], 0
    v_exp_f32 v168, v168
    v_exp_f32 v169, v169
    v_exp_f32 v170, v170
    v_mfma_f32_32x32x16_bf16 v[148:163], v[124:127], v[108:111], v[148:163]
    v_exp_f32 v171, v171
    v_exp_f32 v172, v172
    v_exp_f32 v173, v173
    v_exp_f32 v174, v174
    v_smfmac_f32_32x32x32_bf16 v[196:211], v[132:135], v[164:171], v14
    ds_read_b128 v[140:143], v13 offset:1280
    ds_read_b128 v[144:147], v13 offset:1920
    v_exp_f32 v175, v175
    v_exp_f32 v176, v176
    v_exp_f32 v177, v177
    v_mfma_f32_32x32x8_bf16 v[16:31], v[216:217], v[216:217], 0
    v_exp_f32 v178, v178
    v_exp_f32 v179, v179
    v_exp_f32 v148, v148
    v_exp_f32 v149, v149
    v_smfmac_f32_32x32x32_bf16 v[196:211], v[136:139], v[172:179], v14
    s_add_u32 s18, s17, 139264
    s_add_u32 s19, s18, 139264
    s_add_u32 s20, s19, 139264
    s_add_u32 s21, s20, 139264
    s_mov_b32 s54, s42
    v_exp_f32 v150, v150
    v_exp_f32 v151, v151
    v_mfma_f32_32x32x8_bf16 v[164:179], v[130:131], v[118:119], 0
    v_exp_f32 v152, v152
    v_exp_f32 v153, v153
    v_exp_f32 v154, v154
    v_mfma_f32_32x32x16_bf16 v[164:179], v[124:127], v[112:115], v[164:179]
    s_waitcnt lgkmcnt(0)
    ds_read_b128 v[120:123], v10 offset:3072
    ds_read_b64 v[128:129], v12 offset:3072
    v_exp_f32 v155, v155
    v_exp_f32 v156, v156
    v_exp_f32 v157, v157
    v_exp_f32 v158, v158
    v_smfmac_f32_32x32x32_bf16 v[180:195], v[140:143], v[148:155], v14
    v_exp_f32 v159, v159
    v_exp_f32 v160, v160
    v_exp_f32 v161, v161
    v_mfma_f32_32x32x8_bf16 v[32:47], v[216:217], v[216:217], 0
    v_exp_f32 v162, v162
    v_exp_f32 v163, v163
    s_setprio 1
    v_exp_f32 v164, v164
    v_exp_f32 v165, v165
    v_smfmac_f32_32x32x32_bf16 v[180:195], v[144:147], v[156:163], v14
    s_waitcnt lgkmcnt(0)
    s_mul_i32 s4, s36, 6144
    s_add_u32 s43, s4, 47616
    s_add_u32 s5, s4, 97792
    s_cmp_ge_u32 s36, 3
    s_cselect_b32 s43, s5, s43
    s_add_u32 s5, s4, 100352
    s_cmp_ge_u32 s36, 5
    s_cselect_b32 s43, s5, s43
    s_add_u32 s44, s43, 3072
    s_cmp_eq_u32 s36, 2
    s_cselect_b32 s44, 113152, s44
    v_exp_f32 v166, v166
    v_exp_f32 v167, v167
    v_mfma_f32_32x32x8_bf16 v[148:163], v[128:129], v[116:117], 0
    v_exp_f32 v168, v168
    v_exp_f32 v169, v169
    v_exp_f32 v170, v170
    v_mfma_f32_32x32x16_bf16 v[148:163], v[120:123], v[108:111], v[148:163]
    v_exp_f32 v171, v171
    v_exp_f32 v172, v172
    v_exp_f32 v173, v173
    v_exp_f32 v174, v174
    v_smfmac_f32_32x32x32_bf16 v[196:211], v[140:143], v[164:171], v14
    ds_read_b128 v[132:135], v13 offset:2560
    ds_read_b128 v[136:139], v13 offset:3200
    v_exp_f32 v175, v175
    v_exp_f32 v176, v176
    v_exp_f32 v177, v177
    v_mfma_f32_32x32x8_bf16 v[48:63], v[216:217], v[216:217], 0
    v_exp_f32 v178, v178
    v_exp_f32 v179, v179
    s_setprio 0
    v_exp_f32 v148, v148
    v_exp_f32 v149, v149
    v_smfmac_f32_32x32x32_bf16 v[196:211], v[144:147], v[172:179], v14
    v_exp_f32 v150, v150
    v_exp_f32 v151, v151
    v_mfma_f32_32x32x8_bf16 v[164:179], v[128:129], v[118:119], 0
    v_exp_f32 v152, v152
    v_exp_f32 v153, v153
    v_exp_f32 v154, v154
    v_mfma_f32_32x32x16_bf16 v[164:179], v[120:123], v[112:115], v[164:179]
    s_waitcnt lgkmcnt(0)
    ds_read_b128 v[124:127], v10 offset:3584
    ds_read_b64 v[130:131], v12 offset:3584
    v_exp_f32 v155, v155
    v_exp_f32 v156, v156
    v_exp_f32 v157, v157
    v_exp_f32 v158, v158
    v_smfmac_f32_32x32x32_bf16 v[180:195], v[132:135], v[148:155], v14
    v_exp_f32 v159, v159
    v_exp_f32 v160, v160
    v_exp_f32 v161, v161
    v_mfma_f32_32x32x8_bf16 v[64:79], v[216:217], v[216:217], 0
    v_exp_f32 v162, v162
    v_exp_f32 v163, v163
    v_exp_f32 v164, v164
    v_exp_f32 v165, v165
    v_smfmac_f32_32x32x32_bf16 v[180:195], v[136:139], v[156:163], v14
    s_waitcnt lgkmcnt(0)
    s_waitcnt vmcnt(0)
    s_barrier
    s_cmp_lg_u32 s36, 0
    s_cbranch_scc1 F_pub42
    s_lshl_b32 s4, s2, 5
    s_add_u32 s4, s4, 19678848
    s_add_u32 s5, s32, 4
    v_mov_b32 v240, s5
    v_mov_b32 v241, s33
    s_mov_b64 exec, 1
    buffer_store_dwordx2 v[240:241], off, s[24:27], s4 sc0 sc1
    s_mov_b64 exec, -1
F_pub42:
    v_exp_f32 v166, v166
    v_exp_f32 v167, v167
    v_mfma_f32_32x32x8_bf16 v[148:163], v[130:131], v[116:117], 0
    v_exp_f32 v168, v168
    v_exp_f32 v169, v169
    v_exp_f32 v170, v170
    v_mfma_f32_32x32x16_bf16 v[148:163], v[124:127], v[108:111], v[148:163]
    v_exp_f32 v171, v171
    v_exp_f32 v172, v172
    v_exp_f32 v173, v173
    v_exp_f32 v174, v174
    v_smfmac_f32_32x32x32_bf16 v[196:211], v[132:135], v[164:171], v14
    ds_read_b128 v[140:143], v13 offset:3840
    ds_read_b128 v[144:147], v13 offset:4480
    v_exp_f32 v175, v175
    v_exp_f32 v176, v176
    v_exp_f32 v177, v177
    v_mfma_f32_32x32x8_bf16 v[80:95], v[216:217], v[216:217], 0
    v_exp_f32 v178, v178
    v_exp_f32 v179, v179
    s_setprio 3
    v_exp_f32 v148, v148
    v_exp_f32 v149, v149
    v_smfmac_f32_32x32x32_bf16 v[196:211], v[136:139], v[172:179], v14
    s_add_u32 m0, s64, s67
    s_nop 0
    buffer_load_dwordx4 v1, s[24:27], s62 offen sc1 lds
    s_add_u32 m0, m0, 1024
    s_add_u32 s4, s62, 32768
    buffer_load_dwordx4 v1, s[24:27], s4 offen sc1 lds
    s_add_u32 m0, m0, 1024
    s_add_u32 s4, s62, s61
    buffer_load_dwordx4 v1, s[24:27], s4 offen sc1 lds
    v_exp_f32 v150, v150
    v_exp_f32 v151, v151
    v_mfma_f32_32x32x8_bf16 v[164:179], v[130:131], v[118:119], 0
    v_exp_f32 v152, v152
    v_exp_f32 v153, v153
    v_exp_f32 v154, v154
    v_mfma_f32_32x32x16_bf16 v[164:179], v[124:127], v[112:115], v[164:179]
    s_waitcnt lgkmcnt(0)
    ds_read_b128 v[120:123], v10 offset:6144
    ds_read_b64 v[128:129], v12 offset:6144
    v_exp_f32 v155, v155
    v_exp_f32 v156, v156
    v_exp_f32 v157, v157
    v_exp_f32 v158, v158
    v_smfmac_f32_32x32x32_bf16 v[180:195], v[140:143], v[148:155], v14
    v_exp_f32 v159, v159
    v_exp_f32 v160, v160
    v_exp_f32 v161, v161
    v_exp_f32 v162, v162
    v_exp_f32 v163, v163
    v_exp_f32 v164, v164
    v_exp_f32 v165, v165
    v_smfmac_f32_32x32x32_bf16 v[180:195], v[144:147], v[156:163], v14
    s_waitcnt lgkmcnt(0)
    s_add_u32 m0, s65, s67
    s_add_u32 s62, s62, 4096
    buffer_load_dwordx4 v1, s[24:27], s63 offen sc1 lds
    buffer_load_dwordx4 v1, s[24:27], s63 offen offset:1024 sc1 lds
    buffer_load_dwordx4 v1, s[24:27], s63 offen offset:2048 sc1 lds
    v_exp_f32 v166, v166
    v_exp_f32 v167, v167
    v_mfma_f32_32x32x8_bf16 v[148:163], v[128:129], v[116:117], 0
    v_exp_f32 v168, v168
    v_exp_f32 v169, v169
    v_exp_f32 v170, v170
    v_mfma_f32_32x32x16_bf16 v[148:163], v[120:123], v[108:111], v[148:163]
    v_exp_f32 v171, v171
    v_exp_f32 v172, v172
    v_exp_f32 v173, v173
    v_exp_f32 v174, v174
    v_smfmac_f32_32x32x32_bf16 v[196:211], v[140:143], v[164:171], v14
    ds_read_b128 v[132:135], v13 offset:5120
    ds_read_b128 v[136:139], v13 offset:5760
    v_exp_f32 v175, v175
    v_exp_f32 v176, v176
    v_exp_f32 v177, v177
    v_exp_f32 v178, v178
    v_exp_f32 v179, v179
    v_exp_f32 v148, v148
    v_exp_f32 v149, v149
    v_smfmac_f32_32x32x32_bf16 v[196:211], v[144:147], v[172:179], v14
    s_add_u32 s63, s63, 10240
    s_mov_b32 s67, 0
    v_exp_f32 v150, v150
    v_exp_f32 v151, v151
    v_mfma_f32_32x32x8_bf16 v[164:179], v[128:129], v[118:119], 0
    v_exp_f32 v152, v152
    v_exp_f32 v153, v153
    v_exp_f32 v154, v154
    v_mfma_f32_32x32x16_bf16 v[164:179], v[120:123], v[112:115], v[164:179]
    s_waitcnt lgkmcnt(0)
    ds_read_b128 v[124:127], v10 offset:6656
    ds_read_b64 v[130:131], v12 offset:6656
    v_exp_f32 v155, v155
    v_exp_f32 v156, v156
    v_exp_f32 v157, v157
    v_exp_f32 v158, v158
    v_smfmac_f32_32x32x32_bf16 v[180:195], v[132:135], v[148:155], v14
    v_exp_f32 v159, v159
    v_exp_f32 v160, v160
    v_exp_f32 v161, v161
    v_exp_f32 v162, v162
    v_exp_f32 v163, v163
    s_setprio 2
    v_exp_f32 v164, v164
    v_exp_f32 v165, v165
    v_smfmac_f32_32x32x32_bf16 v[180:195], v[136:139], v[156:163], v14
    s_waitcnt lgkmcnt(0)
    v_exp_f32 v166, v166
    v_exp_f32 v167, v167
    v_mfma_f32_32x32x8_bf16 v[148:163], v[130:131], v[116:117], 0
    v_exp_f32 v168, v168
    v_exp_f32 v169, v169
    v_exp_f32 v170, v170
    v_mfma_f32_32x32x16_bf16 v[148:163], v[124:127], v[108:111], v[148:163]
    v_exp_f32 v171, v171
    v_exp_f32 v172, v172
    v_exp_f32 v173, v173
    v_exp_f32 v174, v174
    v_smfmac_f32_32x32x32_bf16 v[196:211], v[132:135], v[164:171], v14
    ds_read_b128 v[140:143], v13 offset:6400
    ds_read_b128 v[144:147], v13 offset:7040
    v_exp_f32 v175, v175
    v_exp_f32 v176, v176
    v_exp_f32 v177, v177
    v_exp_f32 v178, v178
    v_exp_f32 v179, v179
    v_exp_f32 v148, v148
    v_exp_f32 v149, v149
    v_smfmac_f32_32x32x32_bf16 v[196:211], v[136:139], v[172:179], v14
    v_exp_f32 v150, v150
    v_exp_f32 v151, v151
    v_mfma_f32_32x32x8_bf16 v[164:179], v[130:131], v[118:119], 0
    v_exp_f32 v152, v152
    v_exp_f32 v153, v153
    v_exp_f32 v154, v154
    v_mfma_f32_32x32x16_bf16 v[164:179], v[124:127], v[112:115], v[164:179]
    s_waitcnt lgkmcnt(0)
    ds_read_b128 v[120:123], v10 offset:9216
    ds_read_b64 v[128:129], v12 offset:9216
    v_exp_f32 v155, v155
    v_exp_f32 v156, v156
    v_exp_f32 v157, v157
    v_exp_f32 v158, v158
    v_smfmac_f32_32x32x32_bf16 v[180:195], v[140:143], v[148:155], v14
    v_exp_f32 v159, v159
    v_exp_f32 v160, v160
    v_exp_f32 v161, v161
    v_exp_f32 v162, v162
    v_exp_f32 v163, v163
    v_exp_f32 v164, v164
    v_exp_f32 v165, v165
    v_smfmac_f32_32x32x32_bf16 v[180:195], v[144:147], v[156:163], v14
    s_waitcnt lgkmcnt(0)
    v_exp_f32 v166, v166
    v_exp_f32 v167, v167
    v_mfma_f32_32x32x8_bf16 v[148:163], v[128:129], v[116:117], 0
    v_exp_f32 v168, v168
    v_exp_f32 v169, v169
    v_exp_f32 v170, v170
    v_mfma_f32_32x32x16_bf16 v[148:163], v[120:123], v[108:111], v[148:163]
    v_exp_f32 v171, v171
    v_exp_f32 v172, v172
    v_exp_f32 v173, v173
    v_exp_f32 v174, v174
    v_smfmac_f32_32x32x32_bf16 v[196:211], v[140:143], v[164:171], v14
    ds_read_b128 v[132:135], v13 offset:7680
    ds_read_b128 v[136:139], v13 offset:8320
    v_exp_f32 v175, v175
    v_exp_f32 v176, v176
    v_exp_f32 v177, v177
    v_exp_f32 v178, v178
    v_exp_f32 v179, v179
    s_setprio 1
    v_exp_f32 v148, v148
    v_exp_f32 v149, v149
    v_smfmac_f32_32x32x32_bf16 v[196:211], v[144:147], v[172:179], v14
    v_exp_f32 v150, v150
    v_exp_f32 v151, v151
    v_mfma_f32_32x32x8_bf16 v[164:179], v[128:129], v[118:119], 0
    v_exp_f32 v152, v152
    v_exp_f32 v153, v153
    v_exp_f32 v154, v154
    v_mfma_f32_32x32x16_bf16 v[164:179], v[120:123], v[112:115], v[164:179]
    s_waitcnt lgkmcnt(0)
    ds_read_b128 v[124:127], v10 offset:9728
    ds_read_b64 v[130:131], v12 offset:9728
    v_exp_f32 v155, v155
    v_exp_f32 v156, v156
    v_exp_f32 v157, v157
    v_exp_f32 v158, v158
    v_smfmac_f32_32x32x32_bf16 v[180:195], v[132:135], v[148:155], v14
    v_exp_f32 v159, v159
    v_exp_f32 v160, v160
    v_exp_f32 v161, v161
    v_exp_f32 v162, v162
    v_exp_f32 v163, v163
    s_setprio 0
    v_exp_f32 v164, v164
    v_exp_f32 v165, v165
    v_smfmac_f32_32x32x32_bf16 v[180:195], v[136:139], v[156:163], v14
    s_waitcnt lgkmcnt(0)
    v_exp_f32 v166, v166
    v_exp_f32 v167, v167
    v_mfma_f32_32x32x8_bf16 v[148:163], v[130:131], v[116:117], 0
    v_exp_f32 v168, v168
    v_exp_f32 v169, v169
    v_exp_f32 v170, v170
    v_mfma_f32_32x32x16_bf16 v[148:163], v[124:127], v[108:111], v[148:163]
    v_exp_f32 v171, v171
    v_exp_f32 v172, v172
    v_exp_f32 v173, v173
    v_exp_f32 v174, v174
    v_smfmac_f32_32x32x32_bf16 v[196:211], v[132:135], v[164:171], v14
    ds_read_b128 v[140:143], v13 offset:8960
    ds_read_b128 v[144:147], v13 offset:9600
    v_exp_f32 v175, v175
    v_exp_f32 v176, v176
    v_exp_f32 v177, v177
    buffer_load_dwordx2 v[240:241], v11, s[24:27], 0 offen sc1
    v_exp_f32 v178, v178
    v_exp_f32 v179, v179
    v_exp_f32 v148, v148
    v_exp_f32 v149, v149
    v_smfmac_f32_32x32x32_bf16 v[196:211], v[136:139], v[172:179], v14
    s_waitcnt lgkmcnt(0)
    s_waitcnt vmcnt(1)
    s_barrier
    s_setprio 3
    v_exp_f32 v150, v150
    v_exp_f32 v151, v151
    v_mfma_f32_32x32x8_bf16 v[164:179], v[130:131], v[118:119], 0
    v_exp_f32 v152, v152
    v_exp_f32 v153, v153
    v_exp_f32 v154, v154
    v_mfma_f32_32x32x16_bf16 v[164:179], v[124:127], v[112:115], v[164:179]
    v_add_u32 v10, s68, v10
    s_mov_b64 exec, s[14:15]
    v_add_u32 v12, s68, v12
    s_mov_b64 exec, s[12:13]
    v_add_u32 v13, s68, v13
    s_mov_b64 exec, -1
    ds_read_b128 v[120:123], v10 offset:0
    ds_read_b64 v[128:129], v12 offset:0
    v_exp_f32 v155, v155
    v_exp_f32 v156, v156
    v_exp_f32 v157, v157
    v_exp_f32 v158, v158
    v_smfmac_f32_32x32x32_bf16 v[180:195], v[140:143], v[148:155], v14
    s_add_u32 s4, s32, 4
    s_waitcnt vmcnt(0)
    v_xor_b32 v241, s33, v241
    v_subrev_u32 v240, s4, v240
    v_lshrrev_b32 v240, 3, v240
    v_or_b32 v241, v241, v240
    v_cmp_ne_u32 vcc, 0, v241
    s_nop 4
    s_cbranch_vccnz F_spin44
F_ok43:
    buffer_load_dwordx4 v[212:215], v1, s[24:27], s16 offen offset:0 sc1
    buffer_load_dwordx4 v[220:223], v1, s[24:27], s17 offen offset:0 sc1
    buffer_load_dwordx4 v[224:227], v1, s[24:27], s18 offen offset:0 sc1
    buffer_load_dwordx4 v[228:231], v1, s[24:27], s19 offen offset:0 sc1
    buffer_load_dwordx4 v[232:235], v1, s[24:27], s20 offen offset:0 sc1
    buffer_load_dwordx4 v[236:239], v1, s[24:27], s21 offen offset:0 sc1
    s_add_u32 s16, s16, 1024
    s_add_u32 s17, s17, 1024
    s_add_u32 s18, s18, 1024
    s_add_u32 s19, s19, 1024
    s_add_u32 s20, s20, 1024
    s_add_u32 s21, s21, 1024
    s_add_u32 m0, s64, s67
    s_nop 0
    buffer_load_dwordx4 v1, s[24:27], s62 offen sc1 lds
    s_add_u32 m0, m0, 1024
    s_add_u32 s4, s62, 32768
    buffer_load_dwordx4 v1, s[24:27], s4 offen sc1 lds
    s_add_u32 m0, m0, 1024
    s_add_u32 s4, s62, s61
    buffer_load_dwordx4 v1, s[24:27], s4 offen sc1 lds
    s_add_u32 m0, s65, s67
    s_add_u32 s62, s62, 4096
    buffer_load_dwordx4 v1, s[24:27], s63 offen sc1 lds
    buffer_load_dwordx4 v1, s[24:27], s63 offen offset:1024 sc1 lds
    buffer_load_dwordx4 v1, s[24:27], s63 offen offset:2048 sc1 lds
    s_add_u32 s63, s63, 10240
    s_add_u32 s67, s67, s68
    s_sub_u32 s68, 0, s68
    s_add_u32 s66, s66, 1
    v_exp_f32 v159, v159
    v_exp_f32 v160, v160
    v_exp_f32 v161, v161
    v_exp_f32 v162, v162
    v_exp_f32 v163, v163
    v_exp_f32 v164, v164
    v_exp_f32 v165, v165
    v_smfmac_f32_32x32x32_bf16 v[180:195], v[144:147], v[156:163], v14
    s_waitcnt lgkmcnt(0)
    v_exp_f32 v166, v166
    v_exp_f32 v167, v167
    v_mfma_f32_32x32x8_bf16 v[148:163], v[128:129], v[116:117], 0
    v_exp_f32 v168, v168
    v_exp_f32 v169, v169
    v_exp_f32 v170, v170
    v_mfma_f32_32x32x16_bf16 v[148:163], v[120:123], v[108:111], v[148:163]
    v_exp_f32 v171, v171
    v_exp_f32 v172, v172
    v_exp_f32 v173, v173
    v_exp_f32 v174, v174
    v_smfmac_f32_32x32x32_bf16 v[196:211], v[140:143], v[164:171], v14
    ds_read_b128 v[132:135], v13 offset:0
    ds_read_b128 v[136:139], v13 offset:640
    v_exp_f32 v175, v175
    v_exp_f32 v176, v176
    v_exp_f32 v177, v177
    v_exp_f32 v178, v178
    v_exp_f32 v179, v179
    .p2align 6
F_loop:
    v_exp_f32 v148, v148
    v_exp_f32 v149, v149
    v_smfmac_f32_32x32x32_bf16 v[196:211], v[144:147], v[172:179], v14
    v_exp_f32 v150, v150
    v_exp_f32 v151, v151
    v_exp_f32 v152, v152
    v_mfma_f32_32x32x8_bf16 v[164:179], v[128:129], v[118:119], 0
    v_exp_f32 v153, v153
    v_exp_f32 v154, v154
    v_exp_f32 v155, v155
    v_mfma_f32_32x32x16_bf16 v[164:179], v[120:123], v[112:115], v[164:179]
    s_waitcnt lgkmcnt(0)
    ds_read_b128 v[124:127], v10 offset:512
    ds_read_b64 v[130:131], v12 offset:512
    v_exp_f32 v156, v156
    v_exp_f32 v157, v157
    v_exp_f32 v158, v158
    v_smfmac_f32_32x32x32_bf16 v[180:195], v[132:135], v[148:155], v14
    v_exp_f32 v159, v159
    v_exp_f32 v160, v160
    v_exp_f32 v161, v161
    s_waitcnt vmcnt(4)
    v_mfma_f32_32x32x16_bf16 v[16:31], v[212:215], v[220:223], v[16:31]
    buffer_load_dwordx4 v[220:223], v1, s[24:27], s17 offen offset:0 sc1
    buffer_load_dwordx4 v[216:219], v1, s[24:27], s16 offen offset:0 sc1
    v_exp_f32 v162, v162
    v_exp_f32 v163, v163
    v_exp_f32 v164, v164
    v_exp_f32 v165, v165
    v_smfmac_f32_32x32x32_bf16 v[180:195], v[136:139], v[156:163], v14
    s_waitcnt lgkmcnt(0)
    v_exp_f32 v166, v166
    v_exp_f32 v167, v167
    v_exp_f32 v168, v168
    v_mfma_f32_32x32x8_bf16 v[148:163], v[130:131], v[116:117], 0
    v_exp_f32 v169, v169
    v_exp_f32 v170, v170
    v_exp_f32 v171, v171
    v_mfma_f32_32x32x16_bf16 v[148:163], v[124:127], v[108:111], v[148:163]
    v_exp_f32 v172, v172
    v_exp_f32 v173, v173
    v_exp_f32 v174, v174
    v_smfmac_f32_32x32x32_bf16 v[196:211], v[132:135], v[164:171], v14
    ds_read_b128 v[140:143], v13 offset:1280
    ds_read_b128 v[144:147], v13 offset:1920
    v_exp_f32 v175, v175
    v_exp_f32 v176, v176
    v_exp_f32 v177, v177
    s_waitcnt vmcnt(5)
    v_mfma_f32_32x32x16_bf16 v[32:47], v[212:215], v[224:227], v[32:47]
    buffer_load_dwordx4 v[224:227], v1, s[24:27], s18 offen offset:0 sc1
    v_exp_f32 v178, v178
    v_exp_f32 v179, v179
    v_exp_f32 v148, v148
    v_exp_f32 v149, v149
    v_smfmac_f32_32x32x32_bf16 v[196:211], v[136:139], v[172:179], v14
    v_exp_f32 v150, v150
    v_exp_f32 v151, v151
    v_exp_f32 v152, v152
    v_mfma_f32_32x32x8_bf16 v[164:179], v[130:131], v[118:119], 0
    v_exp_f32 v153, v153
    v_exp_f32 v154, v154
    v_exp_f32 v155, v155
    v_mfma_f32_32x32x16_bf16 v[164:179], v[124:127], v[112:115], v[164:179]
    s_waitcnt lgkmcnt(0)
    ds_read_b128 v[120:123], v10 offset:3072
    ds_read_b64 v[128:129], v12 offset:3072
    v_exp_f32 v156, v156
    v_exp_f32 v157, v157
    v_exp_f32 v158, v158
    v_smfmac_f32_32x32x32_bf16 v[180:195], v[140:143], v[148:155], v14
    s_mov_b32 m0, s43
    s_nop 0
    buffer_load_dwordx4 v1, s[24:27], s54 offen offset:0 sc1 lds
    v_exp_f32 v159, v159
    v_exp_f32 v160, v160
    v_exp_f32 v161, v161
    s_waitcnt vmcnt(6)
    v_mfma_f32_32x32x16_bf16 v[48:63], v[212:215], v[228:231], v[48:63]
    buffer_load_dwordx4 v[228:231], v1, s[24:27], s19 offen offset:0 sc1
    v_exp_f32 v162, v162
    v_exp_f32 v163, v163
    v_exp_f32 v164, v164
    v_exp_f32 v165, v165
    v_smfmac_f32_32x32x32_bf16 v[180:195], v[144:147], v[156:163], v14
    s_waitcnt lgkmcnt(0)
    v_exp_f32 v166, v166
    v_exp_f32 v167, v167
    v_mfma_f32_32x32x8_bf16 v[148:163], v[128:129], v[116:117], 0
    v_exp_f32 v168, v168
    v_exp_f32 v169, v169
    v_exp_f32 v170, v170
    v_mfma_f32_32x32x16_bf16 v[148:163], v[120:123], v[108:111], v[148:163]
    v_exp_f32 v171, v171
    v_exp_f32 v172, v172
    v_exp_f32 v173, v173
    s_waitcnt vmcnt(6)
    v_mfma_f32_32x32x16_bf16 v[64:79], v[212:215], v[232:235], v[64:79]
    buffer_load_dwordx4 v[232:235], v1, s[24:27], s20 offen offset:0 sc1
    v_exp_f32 v174, v174
    v_exp_f32 v175, v175
    v_smfmac_f32_32x32x32_bf16 v[196:211], v[140:143], v[164:171], v14
    ds_read_b128 v[132:135], v13 offset:2560
    ds_read_b128 v[136:139], v13 offset:3200
    v_exp_f32 v176, v176
    v_exp_f32 v177, v177
    v_exp_f32 v178, v178
    s_waitcnt vmcnt(6)
    v_mfma_f32_32x32x16_bf16 v[80:95], v[212:215], v[236:239], v[80:95]
    buffer_load_dwordx4 v[236:239], v1, s[24:27], s21 offen offset:0 sc1
    v_exp_f32 v179, v179
    v_exp_f32 v148, v148
    v_exp_f32 v149, v149
    v_smfmac_f32_32x32x32_bf16 v[196:211], v[144:147], v[172:179], v14
    v_exp_f32 v150, v150
    v_exp_f32 v151, v151
    v_exp_f32 v152, v152
    v_mfma_f32_32x32x8_bf16 v[164:179], v[128:129], v[118:119], 0
    v_exp_f32 v153, v153
    v_exp_f32 v154, v154
    v_exp_f32 v155, v155
    v_mfma_f32_32x32x16_bf16 v[164:179], v[120:123], v[112:115], v[164:179]
    s_waitcnt lgkmcnt(0)
    ds_read_b128 v[124:127], v10 offset:3584
    ds_read_b64 v[130:131], v12 offset:3584
    v_exp_f32 v156, v156
    v_exp_f32 v157, v157
    v_exp_f32 v158, v158
    v_smfmac_f32_32x32x32_bf16 v[180:195], v[132:135], v[148:155], v14
    v_exp_f32 v159, v159
    v_exp_f32 v160, v160
    v_exp_f32 v161, v161
    s_waitcnt vmcnt(5)
    v_mfma_f32_32x32x16_bf16 v[16:31], v[216:219], v[220:223], v[16:31]
    buffer_load_dwordx4 v[220:223], v1, s[24:27], s17 offen offset:1024 sc1
    buffer_load_dwordx4 v[212:215], v1, s[24:27], s16 offen offset:1024 sc1
    v_exp_f32 v162, v162
    v_exp_f32 v163, v163
    v_exp_f32 v164, v164
    v_exp_f32 v165, v165
    v_smfmac_f32_32x32x32_bf16 v[180:195], v[136:139], v[156:163], v14
    s_waitcnt lgkmcnt(0)
    v_exp_f32 v166, v166
    v_exp_f32 v167, v167
    v_exp_f32 v168, v168
    v_mfma_f32_32x32x8_bf16 v[148:163], v[130:131], v[116:117], 0
    v_exp_f32 v169, v169
    v_exp_f32 v170, v170
    v_exp_f32 v171, v171
    v_mfma_f32_32x32x16_bf16 v[148:163], v[124:127], v[108:111], v[148:163]
    v_exp_f32 v172, v172
    v_exp_f32 v173, v173
    v_exp_f32 v174, v174
    v_smfmac_f32_32x32x32_bf16 v[196:211], v[132:135], v[164:171], v14
    ds_read_b128 v[140:143], v13 offset:3840
    ds_read_b128 v[144:147], v13 offset:4480
    v_exp_f32 v175, v175
    v_exp_f32 v176, v176
    v_exp_f32 v177, v177
    s_waitcnt vmcnt(6)
    v_mfma_f32_32x32x16_bf16 v[32:47], v[216:219], v[224:227], v[32:47]
    buffer_load_dwordx4 v[224:227], v1, s[24:27], s18 offen offset:1024 sc1
    v_exp_f32 v178, v178
    v_exp_f32 v179, v179
    v_exp_f32 v148, v148
    v_exp_f32 v149, v149
    v_smfmac_f32_32x32x32_bf16 v[196:211], v[136:139], v[172:179], v14
    v_exp_f32 v150, v150
    v_exp_f32 v151, v151
    v_exp_f32 v152, v152
    v_mfma_f32_32x32x8_bf16 v[164:179], v[130:131], v[118:119], 0
    v_exp_f32 v153, v153
    v_exp_f32 v154, v154
    v_exp_f32 v155, v155
    v_mfma_f32_32x32x16_bf16 v[164:179], v[124:127], v[112:115], v[164:179]
    s_waitcnt lgkmcnt(0)
    ds_read_b128 v[120:123], v10 offset:6144
    ds_read_b64 v[128:129], v12 offset:6144
    v_exp_f32 v156, v156
    v_exp_f32 v157, v157
    v_exp_f32 v158, v158
    v_smfmac_f32_32x32x32_bf16 v[180:195], v[140:143], v[148:155], v14
    buffer_load_dwordx4 v1, s[24:27], s54 offen offset:1024 sc1 lds
    v_exp_f32 v159, v159
    v_exp_f32 v160, v160
    v_exp_f32 v161, v161
    s_waitcnt vmcnt(6)
    v_mfma_f32_32x32x16_bf16 v[48:63], v[216:219], v[228:231], v[48:63]
    buffer_load_dwordx4 v[228:231], v1, s[24:27], s19 offen offset:1024 sc1
    v_exp_f32 v162, v162
    v_exp_f32 v163, v163
    v_exp_f32 v164, v164
    v_exp_f32 v165, v165
    v_smfmac_f32_32x32x32_bf16 v[180:195], v[144:147], v[156:163], v14
    s_waitcnt lgkmcnt(0)
    v_exp_f32 v166, v166
    v_exp_f32 v167, v167
    v_mfma_f32_32x32x8_bf16 v[148:163], v[128:129], v[116:117], 0
    v_exp_f32 v168, v168
    v_exp_f32 v169, v169
    v_exp_f32 v170, v170
    v_mfma_f32_32x32x16_bf16 v[148:163], v[120:123], v[108:111], v[148:163]
    s_branch F_pg7k
.p2align 12
F_pg7:
    s_setpc_b64 s[6:7]
F_pg7k:
    v_exp_f32 v171, v171
    v_exp_f32 v172, v172
    v_exp_f32 v173, v173
    s_waitcnt vmcnt(6)
    v_mfma_f32_32x32x16_bf16 v[64:79], v[216:219], v[232:235], v[64:79]
    buffer_load_dwordx4 v[232:235], v1, s[24:27], s20 offen offset:1024 sc1
    v_exp_f32 v174, v174
    v_exp_f32 v175, v175
    v_smfmac_f32_32x32x32_bf16 v[196:211], v[140:143], v[164:171], v14
    ds_read_b128 v[132:135], v13 offset:5120
    ds_read_b128 v[136:139], v13 offset:5760
    v_exp_f32 v176, v176
    v_exp_f32 v177, v177
    v_exp_f32 v178, v178
    s_waitcnt vmcnt(6)
    v_mfma_f32_32x32x16_bf16 v[80:95], v[216:219], v[236:239], v[80:95]
    buffer_load_dwordx4 v[236:239], v1, s[24:27], s21 offen offset:1024 sc1
    v_exp_f32 v179, v179
    s_setprio 2
    v_exp_f32 v148, v148
    v_exp_f32 v149, v149
    v_smfmac_f32_32x32x32_bf16 v[196:211], v[144:147], v[172:179], v14
    v_exp_f32 v150, v150
    v_exp_f32 v151, v151
    v_exp_f32 v152, v152
    v_mfma_f32_32x32x8_bf16 v[164:179], v[128:129], v[118:119], 0
    v_exp_f32 v153, v153
    v_exp_f32 v154, v154
    v_exp_f32 v155, v155
    v_mfma_f32_32x32x16_bf16 v[164:179], v[120:123], v[112:115], v[164:179]
    s_waitcnt lgkmcnt(0)
    ds_read_b128 v[124:127], v10 offset:6656
    ds_read_b64 v[130:131], v12 offset:6656
    v_exp_f32 v156, v156
    v_exp_f32 v157, v157
    v_exp_f32 v158, v158
    v_smfmac_f32_32x32x32_bf16 v[180:195], v[132:135], v[148:155], v14
    v_exp_f32 v159, v159
    v_exp_f32 v160, v160
    v_exp_f32 v161, v161
    s_waitcnt vmcnt(5)
    v_mfma_f32_32x32x16_bf16 v[16:31], v[212:215], v[220:223], v[16:31]
    buffer_load_dwordx4 v[220:223], v1, s[24:27], s17 offen offset:2048 sc1
    buffer_load_dwordx4 v[216:219], v1, s[24:27], s16 offen offset:2048 sc1
    v_exp_f32 v162, v162
    v_exp_f32 v163, v163
    v_exp_f32 v164, v164
    v_exp_f32 v165, v165
    v_smfmac_f32_32x32x32_bf16 v[180:195], v[136:139], v[156:163], v14
    s_waitcnt lgkmcnt(0)
    v_exp_f32 v166, v166
    v_exp_f32 v167, v167
    v_exp_f32 v168, v168
    v_mfma_f32_32x32x8_bf16 v[148:163], v[130:131], v[116:117], 0
    v_exp_f32 v169, v169
    v_exp_f32 v170, v170
    v_exp_f32 v171, v171
    v_mfma_f32_32x32x16_bf16 v[148:163], v[124:127], v[108:111], v[148:163]
    v_exp_f32 v172, v172
    v_exp_f32 v173, v173
    v_exp_f32 v174, v174
    v_smfmac_f32_32x32x32_bf16 v[196:211], v[132:135], v[164:171], v14
    ds_read_b128 v[140:143], v13 offset:6400
    ds_read_b128 v[144:147], v13 offset:7040
    v_exp_f32 v175, v175
    v_exp_f32 v176, v176
    v_exp_f32 v177, v177
    s_waitcnt vmcnt(6)
    v_mfma_f32_32x32x16_bf16 v[32:47], v[212:215], v[224:227], v[32:47]
    buffer_load_dwordx4 v[224:227], v1, s[24:27], s18 offen offset:2048 sc1
    v_exp_f32 v178, v178
    v_exp_f32 v179, v179
    v_exp_f32 v148, v148
    v_exp_f32 v149, v149
    v_smfmac_f32_32x32x32_bf16 v[196:211], v[136:139], v[172:179], v14
    v_exp_f32 v150, v150
    v_exp_f32 v151, v151
    v_exp_f32 v152, v152
    v_mfma_f32_32x32x8_bf16 v[164:179], v[130:131], v[118:119], 0
    v_exp_f32 v153, v153
    v_exp_f32 v154, v154
    v_exp_f32 v155, v155
    v_mfma_f32_32x32x16_bf16 v[164:179], v[124:127], v[112:115], v[164:179]
    s_waitcnt lgkmcnt(0)
    ds_read_b128 v[120:123], v10 offset:9216
    ds_read_b64 v[128:129], v12 offset:9216
    v_exp_f32 v156, v156
    v_exp_f32 v157, v157
    v_exp_f32 v158, v158
    v_smfmac_f32_32x32x32_bf16 v[180:195], v[140:143], v[148:155], v14
    buffer_load_dwordx4 v1, s[24:27], s54 offen offset:2048 sc1 lds
    v_exp_f32 v159, v159
    v_exp_f32 v160, v160
    v_exp_f32 v161, v161
    s_waitcnt vmcnt(6)
    v_mfma_f32_32x32x16_bf16 v[48:63], v[212:215], v[228:231], v[48:63]
    buffer_load_dwordx4 v[228:231], v1, s[24:27], s19 offen offset:2048 sc1
    v_exp_f32 v162, v162
    v_exp_f32 v163, v163
    v_exp_f32 v164, v164
    v_exp_f32 v165, v165
    v_smfmac_f32_32x32x32_bf16 v[180:195], v[144:147], v[156:163], v14
    s_waitcnt lgkmcnt(0)
    v_exp_f32 v166, v166
    v_exp_f32 v167, v167
    v_mfma_f32_32x32x8_bf16 v[148:163], v[128:129], v[116:117], 0
    v_exp_f32 v168, v168
    v_exp_f32 v169, v169
    v_exp_f32 v170, v170
    v_mfma_f32_32x32x16_bf16 v[148:163], v[120:123], v[108:111], v[148:163]
    v_exp_f32 v171, v171
    v_exp_f32 v172, v172
    v_exp_f32 v173, v173
    s_waitcnt vmcnt(6)
    v_mfma_f32_32x32x16_bf16 v[64:79], v[212:215], v[232:235], v[64:79]
    buffer_load_dwordx4 v[232:235], v1, s[24:27], s20 offen offset:2048 sc1
    v_exp_f32 v174, v174
    v_exp_f32 v175, v175
    v_smfmac_f32_32x32x32_bf16 v[196:211], v[140:143], v[164:171], v14
    ds_read_b128 v[132:135], v13 offset:7680
    ds_read_b128 v[136:139], v13 offset:8320
    v_exp_f32 v176, v176
    v_exp_f32 v177, v177
    v_exp_f32 v178, v178
    s_waitcnt vmcnt(6)
    v_mfma_f32_32x32x16_bf16 v[80:95], v[212:215], v[236:239], v[80:95]
    buffer_load_dwordx4 v[236:239], v1, s[24:27], s21 offen offset:2048 sc1
    v_exp_f32 v179, v179
    s_setprio 1
    v_exp_f32 v148, v148
    v_exp_f32 v149, v149
    v_smfmac_f32_32x32x32_bf16 v[196:211], v[144:147], v[172:179], v14
    v_exp_f32 v150, v150
    v_exp_f32 v151, v151
    v_exp_f32 v152, v152
    v_mfma_f32_32x32x8_bf16 v[164:179], v[128:129], v[118:119], 0
    v_exp_f32 v153, v153
    v_exp_f32 v154, v154
    v_exp_f32 v155, v155
    v_mfma_f32_32x32x16_bf16 v[164:179], v[120:123], v[112:115], v[164:179]
    s_waitcnt lgkmcnt(0)
    ds_read_b128 v[124:127], v10 offset:9728
    ds_read_b64 v[130:131], v12 offset:9728
    v_exp_f32 v156, v156
    v_exp_f32 v157, v157
    v_exp_f32 v158, v158
    v_smfmac_f32_32x32x32_bf16 v[180:195], v[132:135], v[148:155], v14
    v_exp_f32 v159, v159
    v_exp_f32 v160, v160
    v_exp_f32 v161, v161
    s_waitcnt vmcnt(5)
    v_mfma_f32_32x32x16_bf16 v[16:31], v[216:219], v[220:223], v[16:31]
    buffer_load_dwordx4 v[220:223], v1, s[24:27], s17 offen offset:3072 sc1
    buffer_load_dwordx4 v[212:215], v1, s[24:27], s16 offen offset:3072 sc1
    v_exp_f32 v162, v162
    v_exp_f32 v163, v163
    s_setprio 0
    v_exp_f32 v164, v164
    v_exp_f32 v165, v165
    v_smfmac_f32_32x32x32_bf16 v[180:195], v[136:139], v[156:163], v14
    s_waitcnt lgkmcnt(0)
    v_exp_f32 v166, v166
    v_exp_f32 v167, v167
    v_exp_f32 v168, v168
    v_mfma_f32_32x32x8_bf16 v[148:163], v[130:131], v[116:117], 0
    v_exp_f32 v169, v169
    v_exp_f32 v170, v170
    v_exp_f32 v171, v171
    v_mfma_f32_32x32x16_bf16 v[148:163], v[124:127], v[108:111], v[148:163]
    v_exp_f32 v172, v172
    v_exp_f32 v173, v173
    v_exp_f32 v174, v174
    v_smfmac_f32_32x32x32_bf16 v[196:211], v[132:135], v[164:171], v14
    ds_read_b128 v[140:143], v13 offset:8960
    ds_read_b128 v[144:147], v13 offset:9600
    v_exp_f32 v175, v175
    v_exp_f32 v176, v176
    v_exp_f32 v177, v177
    s_waitcnt vmcnt(6)
    v_mfma_f32_32x32x16_bf16 v[32:47], v[216:219], v[224:227], v[32:47]
    buffer_load_dwordx4 v[224:227], v1, s[24:27], s18 offen offset:3072 sc1
    v_exp_f32 v178, v178
    v_exp_f32 v179, v179
    v_exp_f32 v148, v148
    v_exp_f32 v149, v149
    v_smfmac_f32_32x32x32_bf16 v[196:211], v[136:139], v[172:179], v14
    s_waitcnt lgkmcnt(0)
    s_waitcnt vmcnt(12)
    s_barrier
    s_setprio 3
    v_exp_f32 v150, v150
    v_exp_f32 v151, v151
    v_exp_f32 v152, v152
    v_mfma_f32_32x32x8_bf16 v[164:179], v[130:131], v[118:119], 0
    v_exp_f32 v153, v153
    v_exp_f32 v154, v154
    v_exp_f32 v155, v155
    v_mfma_f32_32x32x16_bf16 v[164:179], v[124:127], v[112:115], v[164:179]
    v_add_u32 v10, s68, v10
    s_mov_b64 exec, s[14:15]
    v_add_u32 v12, s68, v12
    s_mov_b64 exec, s[12:13]
    v_add_u32 v13, s68, v13
    s_mov_b64 exec, -1
    ds_read_b128 v[120:123], v10 offset:0
    ds_read_b64 v[128:129], v12 offset:0
    v_exp_f32 v156, v156
    v_exp_f32 v157, v157
    v_exp_f32 v158, v158
    v_smfmac_f32_32x32x32_bf16 v[180:195], v[140:143], v[148:155], v14
    s_cmp_ge_u32 s66, 4
    s_cbranch_scc1 F_nokv
    s_add_u32 m0, s64, s67
    s_nop 0
    buffer_load_dwordx4 v1, s[24:27], s62 offen sc1 lds
    s_add_u32 m0, m0, 1024
    s_add_u32 s4, s62, 32768
    buffer_load_dwordx4 v1, s[24:27], s4 offen sc1 lds
    s_add_u32 m0, m0, 1024
    s_add_u32 s4, s62, s61
    buffer_load_dwordx4 v1, s[24:27], s4 offen sc1 lds
    s_add_u32 m0, s65, s67
    s_add_u32 s62, s62, 4096
    buffer_load_dwordx4 v1, s[24:27], s63 offen sc1 lds
    buffer_load_dwordx4 v1, s[24:27], s63 offen offset:1024 sc1 lds
    buffer_load_dwordx4 v1, s[24:27], s63 offen offset:2048 sc1 lds
    s_add_u32 s63, s63, 10240
F_nokv:
    s_add_u32 s67, s67, s68
    s_sub_u32 s68, 0, s68
    s_add_u32 s66, s66, 1
    v_exp_f32 v159, v159
    v_exp_f32 v160, v160
    v_exp_f32 v161, v161
    s_waitcnt vmcnt(5)
    v_mfma_f32_32x32x16_bf16 v[48:63], v[216:219], v[228:231], v[48:63]
    buffer_load_dwordx4 v[228:231], v1, s[24:27], s19 offen offset:3072 sc1
    v_exp_f32 v162, v162
    v_exp_f32 v163, v163
    v_exp_f32 v164, v164
    v_exp_f32 v165, v165
    v_smfmac_f32_32x32x32_bf16 v[180:195], v[144:147], v[156:163], v14
    s_waitcnt lgkmcnt(0)
    v_exp_f32 v166, v166
    v_exp_f32 v167, v167
    v_mfma_f32_32x32x8_bf16 v[148:163], v[128:129], v[116:117], 0
    v_exp_f32 v168, v168
    v_exp_f32 v169, v169
    v_exp_f32 v170, v170
    v_mfma_f32_32x32x16_bf16 v[148:163], v[120:123], v[108:111], v[148:163]
    v_exp_f32 v171, v171
    v_exp_f32 v172, v172
    v_exp_f32 v173, v173
    s_waitcnt vmcnt(5)
    v_mfma_f32_32x32x16_bf16 v[64:79], v[216:219], v[232:235], v[64:79]
    buffer_load_dwordx4 v[232:235], v1, s[24:27], s20 offen offset:3072 sc1
    v_exp_f32 v174, v174
    v_exp_f32 v175, v175
    v_smfmac_f32_32x32x32_bf16 v[196:211], v[140:143], v[164:171], v14
    ds_read_b128 v[132:135], v13 offset:0
    ds_read_b128 v[136:139], v13 offset:640
    v_exp_f32 v176, v176
    v_exp_f32 v177, v177
    v_exp_f32 v178, v178
    s_waitcnt vmcnt(5)
    v_mfma_f32_32x32x16_bf16 v[80:95], v[216:219], v[236:239], v[80:95]
    buffer_load_dwordx4 v[236:239], v1, s[24:27], s21 offen offset:3072 sc1
    v_exp_f32 v179, v179
    s_add_u32 s16, s16, 4096
    s_add_u32 s17, s17, 4096
    s_add_u32 s18, s18, 4096
    s_add_u32 s19, s19, 4096
    s_add_u32 s20, s20, 4096
    s_add_u32 s21, s21, 4096
    s_add_u32 s54, s54, 139264
    s_xor_b32 s43, s43, s44
    s_xor_b32 s44, s43, s44
    s_xor_b32 s43, s43, s44
    s_cmp_lt_u32 s66, 5
    s_cbranch_scc1 F_loop
    v_exp_f32 v148, v148
    v_exp_f32 v149, v149
    v_smfmac_f32_32x32x32_bf16 v[196:211], v[144:147], v[172:179], v14
    v_exp_f32 v150, v150
    v_exp_f32 v151, v151
    v_exp_f32 v152, v152
    v_mfma_f32_32x32x8_bf16 v[164:179], v[128:129], v[118:119], 0
    v_exp_f32 v153, v153
    v_exp_f32 v154, v154
    v_exp_f32 v155, v155
    v_mfma_f32_32x32x16_bf16 v[164:179], v[120:123], v[112:115], v[164:179]
    s_waitcnt lgkmcnt(0)
    ds_read_b128 v[124:127], v10 offset:512
    ds_read_b64 v[130:131], v12 offset:512
    v_exp_f32 v156, v156
    v_exp_f32 v157, v157
    v_exp_f32 v158, v158
    v_smfmac_f32_32x32x32_bf16 v[180:195], v[132:135], v[148:155], v14
    s_lshl_b32 s4, s38, 16
    s_lshl_b32 s5, s37, 12
    s_add_u32 s4, s4, s5
    s_add_u32 m0, s4, 24576
    s_add_u32 s54, s42, 278528
    buffer_load_dwordx4 v1, s[24:27], s54 offen offset:0 sc1 lds
    v_exp_f32 v159, v159
    v_exp_f32 v160, v160
    v_exp_f32 v161, v161
    s_waitcnt vmcnt(5)
    v_mfma_f32_32x32x16_bf16 v[16:31], v[212:215], v[220:223], v[16:31]
    buffer_load_dwordx4 v[220:223], v1, s[24:27], s17 offen offset:0 sc1
    buffer_load_dwordx4 v[216:219], v1, s[24:27], s16 offen offset:0 sc1
    v_exp_f32 v162, v162
    v_exp_f32 v163, v163
    v_exp_f32 v164, v164
    v_exp_f32 v165, v165
    v_smfmac_f32_32x32x32_bf16 v[180:195], v[136:139], v[156:163], v14
    s_waitcnt lgkmcnt(0)
    v_exp_f32 v166, v166
    v_exp_f32 v167, v167
    v_exp_f32 v168, v168
    v_mfma_f32_32x32x8_bf16 v[148:163], v[130:131], v[116:117], 0
    v_exp_f32 v169, v169
    v_exp_f32 v170, v170
    v_exp_f32 v171, v171
    v_mfma_f32_32x32x16_bf16 v[148:163], v[124:127], v[108:111], v[148:163]
    v_exp_f32 v172, v172
    v_exp_f32 v173, v173
    v_exp_f32 v174, v174
    v_smfmac_f32_32x32x32_bf16 v[196:211], v[132:135], v[164:171], v14
    ds_read_b128 v[140:143], v13 offset:1280
    ds_read_b128 v[144:147], v13 offset:1920
    s_add_u32 s4, s42, 3072
    buffer_load_dwordx4 v[2:5], v1, s[24:27], s4 offen sc1
    v_exp_f32 v175, v175
    v_exp_f32 v176, v176
    v_exp_f32 v177, v177
    s_waitcnt vmcnt(7)
    v_mfma_f32_32x32x16_bf16 v[32:47], v[212:215], v[224:227], v[32:47]
    buffer_load_dwordx4 v[224:227], v1, s[24:27], s18 offen offset:0 sc1
    v_exp_f32 v178, v178
    v_exp_f32 v179, v179
    v_exp_f32 v148, v148
    v_exp_f32 v149, v149
    v_smfmac_f32_32x32x32_bf16 v[196:211], v[136:139], v[172:179], v14
    v_exp_f32 v150, v150
    v_exp_f32 v151, v151
    v_exp_f32 v152, v152
    v_mfma_f32_32x32x8_bf16 v[164:179], v[130:131], v[118:119], 0
    v_exp_f32 v153, v153
    v_exp_f32 v154, v154
    v_exp_f32 v155, v155
    v_mfma_f32_32x32x16_bf16 v[164:179], v[124:127], v[112:115], v[164:179]
    s_waitcnt lgkmcnt(0)
    ds_read_b128 v[120:123], v10 offset:3072
    ds_read_b64 v[128:129], v12 offset:3072
    v_exp_f32 v156, v156
    v_exp_f32 v157, v157
    v_exp_f32 v158, v158
    v_smfmac_f32_32x32x32_bf16 v[180:195], v[140:143], v[148:155], v14
    buffer_load_dwordx4 v1, s[24:27], s54 offen offset:1024 sc1 lds
    v_exp_f32 v159, v159
    v_exp_f32 v160, v160
    v_exp_f32 v161, v161
    s_waitcnt vmcnt(8)
    v_mfma_f32_32x32x16_bf16 v[48:63], v[212:215], v[228:231], v[48:63]
    buffer_load_dwordx4 v[228:231], v1, s[24:27], s19 offen offset:0 sc1
    v_exp_f32 v162, v162
    v_exp_f32 v163, v163
    v_exp_f32 v164, v164
    v_exp_f32 v165, v165
    v_smfmac_f32_32x32x32_bf16 v[180:195], v[144:147], v[156:163], v14
    s_waitcnt lgkmcnt(0)
    v_exp_f32 v166, v166
    v_exp_f32 v167, v167
    v_mfma_f32_32x32x8_bf16 v[148:163], v[128:129], v[116:117], 0
    v_exp_f32 v168, v168
    v_exp_f32 v169, v169
    v_exp_f32 v170, v170
    v_mfma_f32_32x32x16_bf16 v[148:163], v[120:123], v[108:111], v[148:163]
    v_exp_f32 v171, v171
    v_exp_f32 v172, v172
    v_exp_f32 v173, v173
    s_waitcnt vmcnt(8)
    v_mfma_f32_32x32x16_bf16 v[64:79], v[212:215], v[232:235], v[64:79]
    buffer_load_dwordx4 v[232:235], v1, s[24:27], s20 offen offset:0 sc1
    v_exp_f32 v174, v174
    v_exp_f32 v175, v175
    v_smfmac_f32_32x32x32_bf16 v[196:211], v[140:143], v[164:171], v14
    ds_read_b128 v[132:135], v13 offset:2560
    ds_read_b128 v[136:139], v13 offset:3200
    s_add_u32 s4, s42, 4096
    buffer_load_dwordx4 v[6:9], v1, s[24:27], s4 offen sc1
    v_exp_f32 v176, v176
    v_exp_f32 v177, v177
    v_exp_f32 v178, v178
    s_waitcnt vmcnt(9)
    v_mfma_f32_32x32x16_bf16 v[80:95], v[212:215], v[236:239], v[80:95]
    buffer_load_dwordx4 v[236:239], v1, s[24:27], s21 offen offset:0 sc1
    v_exp_f32 v179, v179
    v_exp_f32 v148, v148
    v_exp_f32 v149, v149
    v_smfmac_f32_32x32x32_bf16 v[196:211], v[144:147], v[172:179], v14
    v_exp_f32 v150, v150
    v_exp_f32 v151, v151
    v_exp_f32 v152, v152
    v_mfma_f32_32x32x8_bf16 v[164:179], v[128:129], v[118:119], 0
    v_exp_f32 v153, v153
    v_exp_f32 v154, v154
    v_exp_f32 v155, v155
    v_mfma_f32_32x32x16_bf16 v[164:179], v[120:123], v[112:115], v[164:179]
    s_waitcnt lgkmcnt(0)
    ds_read_b128 v[124:127], v10 offset:3584
    ds_read_b64 v[130:131], v12 offset:3584
    v_exp_f32 v156, v156
    v_exp_f32 v157, v157
    v_exp_f32 v158, v158
    v_smfmac_f32_32x32x32_bf16 v[180:195], v[132:135], v[148:155], v14
    buffer_load_dwordx4 v1, s[24:27], s54 offen offset:2048 sc1 lds
    v_exp_f32 v159, v159
    v_exp_f32 v160, v160
    v_exp_f32 v161, v161
    s_waitcnt vmcnt(8)
    v_mfma_f32_32x32x16_bf16 v[16:31], v[216:219], v[220:223], v[16:31]
    buffer_load_dwordx4 v[220:223], v1, s[24:27], s17 offen offset:1024 sc1
    buffer_load_dwordx4 v[212:215], v1, s[24:27], s16 offen offset:1024 sc1
    v_exp_f32 v162, v162
    v_exp_f32 v163, v163
    v_exp_f32 v164, v164
    v_exp_f32 v165, v165
    v_smfmac_f32_32x32x32_bf16 v[180:195], v[136:139], v[156:163], v14
    s_waitcnt lgkmcnt(0)
    v_exp_f32 v166, v166
    v_exp_f32 v167, v167
    v_exp_f32 v168, v168
    v_mfma_f32_32x32x8_bf16 v[148:163], v[130:131], v[116:117], 0
    v_exp_f32 v169, v169
    v_exp_f32 v170, v170
    v_exp_f32 v171, v171
    v_mfma_f32_32x32x16_bf16 v[148:163], v[124:127], v[108:111], v[148:163]
    v_exp_f32 v172, v172
    v_exp_f32 v173, v173
    v_exp_f32 v174, v174
    v_smfmac_f32_32x32x32_bf16 v[196:211], v[132:135], v[164:171], v14
    ds_read_b128 v[140:143], v13 offset:3840
    ds_read_b128 v[144:147], v13 offset:4480
    s_add_u32 s4, s42, 142336
    buffer_load_dwordx4 v[96:99], v1, s[24:27], s4 offen sc1
    v_exp_f32 v175, v175
    v_exp_f32 v176, v176
    v_exp_f32 v177, v177
    s_waitcnt vmcnt(9)
    v_mfma_f32_32x32x16_bf16 v[32:47], v[216:219], v[224:227], v[32:47]
    buffer_load_dwordx4 v[224:227], v1, s[24:27], s18 offen offset:1024 sc1
    v_exp_f32 v178, v178
    v_exp_f32 v179, v179
    v_exp_f32 v148, v148
    v_exp_f32 v149, v149
    v_smfmac_f32_32x32x32_bf16 v[196:211], v[136:139], v[172:179], v14
    v_exp_f32 v150, v150
    v_exp_f32 v151, v151
    v_exp_f32 v152, v152
    v_mfma_f32_32x32x8_bf16 v[164:179], v[130:131], v[118:119], 0
    v_exp_f32 v153, v153
    v_exp_f32 v154, v154
    v_exp_f32 v155, v155
    v_mfma_f32_32x32x16_bf16 v[164:179], v[124:127], v[112:115], v[164:179]
    s_waitcnt lgkmcnt(0)
    ds_read_b128 v[120:123], v10 offset:6144
    ds_read_b64 v[128:129], v12 offset:6144
    v_exp_f32 v156, v156
    v_exp_f32 v157, v157
    v_exp_f32 v158, v158
    v_smfmac_f32_32x32x32_bf16 v[180:195], v[140:143], v[148:155], v14
    buffer_load_dwordx4 v1, s[24:27], s54 offen offset:3072 sc1 lds
    v_exp_f32 v159, v159
    v_exp_f32 v160, v160
    v_exp_f32 v161, v161
    s_waitcnt vmcnt(9)
    v_mfma_f32_32x32x16_bf16 v[48:63], v[216:219], v[228:231], v[48:63]
    buffer_load_dwordx4 v[228:231], v1, s[24:27], s19 offen offset:1024 sc1
    v_exp_f32 v162, v162
    v_exp_f32 v163, v163
    v_exp_f32 v164, v164
    v_exp_f32 v165, v165
    v_smfmac_f32_32x32x32_bf16 v[180:195], v[144:147], v[156:163], v14
    s_waitcnt lgkmcnt(0)
    v_exp_f32 v166, v166
    v_exp_f32 v167, v167
    v_mfma_f32_32x32x8_bf16 v[148:163], v[128:129], v[116:117], 0
    v_exp_f32 v168, v168
    v_exp_f32 v169, v169
    v_exp_f32 v170, v170
    v_mfma_f32_32x32x16_bf16 v[148:163], v[120:123], v[108:111], v[148:163]
    v_exp_f32 v171, v171
    v_exp_f32 v172, v172
    v_exp_f32 v173, v173
    s_waitcnt vmcnt(9)
    v_mfma_f32_32x32x16_bf16 v[64:79], v[216:219], v[232:235], v[64:79]
    buffer_load_dwordx4 v[232:235], v1, s[24:27], s20 offen offset:1024 sc1
    v_exp_f32 v174, v174
    v_exp_f32 v175, v175
    v_smfmac_f32_32x32x32_bf16 v[196:211], v[140:143], v[164:171], v14
    ds_read_b128 v[132:135], v13 offset:5120
    ds_read_b128 v[136:139], v13 offset:5760
    s_add_u32 s4, s42, 143360
    buffer_load_dwordx4 v[100:103], v1, s[24:27], s4 offen sc1
    v_exp_f32 v176, v176
    v_exp_f32 v177, v177
    v_exp_f32 v178, v178
    s_waitcnt vmcnt(9)
    v_mfma_f32_32x32x16_bf16 v[80:95], v[216:219], v[236:239], v[80:95]
    buffer_load_dwordx4 v[236:239], v1, s[24:27], s21 offen offset:1024 sc1
    v_exp_f32 v179, v179
    v_exp_f32 v148, v148
    v_exp_f32 v149, v149
    v_smfmac_f32_32x32x32_bf16 v[196:211], v[144:147], v[172:179], v14
    v_exp_f32 v150, v150
    v_exp_f32 v151, v151
    v_exp_f32 v152, v152
    v_mfma_f32_32x32x8_bf16 v[164:179], v[128:129], v[118:119], 0
    v_exp_f32 v153, v153
    v_exp_f32 v154, v154
    v_exp_f32 v155, v155
    v_mfma_f32_32x32x16_bf16 v[164:179], v[120:123], v[112:115], v[164:179]
    s_waitcnt lgkmcnt(0)
    ds_read_b128 v[124:127], v10 offset:6656
    ds_read_b64 v[130:131], v12 offset:6656
    v_exp_f32 v156, v156
    v_exp_f32 v157, v157
    v_exp_f32 v158, v158
    v_smfmac_f32_32x32x32_bf16 v[180:195], v[132:135], v[148:155], v14
    s_add_u32 s4, s42, 418816
    buffer_load_dwordx4 v[244:247], v1, s[24:27], s4 offen sc1
    v_exp_f32 v159, v159
    v_exp_f32 v160, v160
    v_exp_f32 v161, v161
    s_waitcnt vmcnt(8)
    v_mfma_f32_32x32x16_bf16 v[16:31], v[212:215], v[220:223], v[16:31]
    buffer_load_dwordx4 v[220:223], v1, s[24:27], s17 offen offset:2048 sc1
    buffer_load_dwordx4 v[216:219], v1, s[24:27], s16 offen offset:2048 sc1
    v_exp_f32 v162, v162
    v_exp_f32 v163, v163
    v_exp_f32 v164, v164
    v_exp_f32 v165, v165
    v_smfmac_f32_32x32x32_bf16 v[180:195], v[136:139], v[156:163], v14
    s_waitcnt lgkmcnt(0)
    v_exp_f32 v166, v166
    v_exp_f32 v167, v167
    v_exp_f32 v168, v168
    v_mfma_f32_32x32x8_bf16 v[148:163], v[130:131], v[116:117], 0
    v_exp_f32 v169, v169
    v_exp_f32 v170, v170
    v_exp_f32 v171, v171
    v_mfma_f32_32x32x16_bf16 v[148:163], v[124:127], v[108:111], v[148:163]
    v_exp_f32 v172, v172
    v_exp_f32 v173, v173
    v_exp_f32 v174, v174
    v_smfmac_f32_32x32x32_bf16 v[196:211], v[132:135], v[164:171], v14
    ds_read_b128 v[140:143], v13 offset:6400
    ds_read_b128 v[144:147], v13 offset:7040
    s_add_u32 s4, s42, 282624
    buffer_load_dwordx4 v[104:107], v1, s[24:27], s4 offen sc1
    v_exp_f32 v175, v175
    v_exp_f32 v176, v176
    v_exp_f32 v177, v177
    s_waitcnt vmcnt(9)
    v_mfma_f32_32x32x16_bf16 v[32:47], v[212:215], v[224:227], v[32:47]
    buffer_load_dwordx4 v[224:227], v1, s[24:27], s18 offen offset:2048 sc1
    v_exp_f32 v178, v178
    v_exp_f32 v179, v179
    s_setprio 2
    v_exp_f32 v148, v148
    v_exp_f32 v149, v149
    v_smfmac_f32_32x32x32_bf16 v[196:211], v[136:139], v[172:179], v14
    v_exp_f32 v150, v150
    v_exp_f32 v151, v151
    v_exp_f32 v152, v152
    v_mfma_f32_32x32x8_bf16 v[164:179], v[130:131], v[118:119], 0
    v_exp_f32 v153, v153
    v_exp_f32 v154, v154
    v_exp_f32 v155, v155
    v_mfma_f32_32x32x16_bf16 v[164:179], v[124:127], v[112:115], v[164:179]
    s_waitcnt lgkmcnt(0)
    ds_read_b128 v[120:123], v10 offset:9216
    ds_read_b64 v[128:129], v12 offset:9216
    v_exp_f32 v156, v156
    v_exp_f32 v157, v157
    v_exp_f32 v158, v158
    v_smfmac_f32_32x32x32_bf16 v[180:195], v[140:143], v[148:155], v14
    s_add_u32 s4, s42, 419840
    buffer_load_dwordx4 v[248:251], v1, s[24:27], s4 offen sc1
    v_exp_f32 v159, v159
    v_exp_f32 v160, v160
    v_exp_f32 v161, v161
    s_waitcnt vmcnt(9)
    v_mfma_f32_32x32x16_bf16 v[48:63], v[212:215], v[228:231], v[48:63]
    buffer_load_dwordx4 v[228:231], v1, s[24:27], s19 offen offset:2048 sc1
    v_exp_f32 v162, v162
    v_exp_f32 v163, v163
    v_exp_f32 v164, v164
    v_exp_f32 v165, v165
    v_smfmac_f32_32x32x32_bf16 v[180:195], v[144:147], v[156:163], v14
    s_waitcnt lgkmcnt(0)
    v_exp_f32 v166, v166
    v_exp_f32 v167, v167
    v_mfma_f32_32x32x8_bf16 v[148:163], v[128:129], v[116:117], 0
    v_exp_f32 v168, v168
    v_exp_f32 v169, v169
    v_exp_f32 v170, v170
    v_mfma_f32_32x32x16_bf16 v[148:163], v[120:123], v[108:111], v[148:163]
    v_exp_f32 v171, v171
    v_exp_f32 v172, v172
    v_exp_f32 v173, v173
    s_waitcnt vmcnt(9)
    v_mfma_f32_32x32x16_bf16 v[64:79], v[212:215], v[232:235], v[64:79]
    buffer_load_dwordx4 v[232:235], v1, s[24:27], s20 offen offset:2048 sc1
    v_exp_f32 v174, v174
    v_exp_f32 v175, v175
    v_smfmac_f32_32x32x32_bf16 v[196:211], v[140:143], v[164:171], v14
    ds_read_b128 v[132:135], v13 offset:7680
    ds_read_b128 v[136:139], v13 offset:8320
    s_add_u32 s4, s42, 417792
    buffer_load_dwordx4 v[240:243], v1, s[24:27], s4 offen sc1
    v_exp_f32 v176, v176
    v_exp_f32 v177, v177
    v_exp_f32 v178, v178
    s_waitcnt vmcnt(9)
    v_mfma_f32_32x32x16_bf16 v[80:95], v[212:215], v[236:239], v[80:95]
    buffer_load_dwordx4 v[236:239], v1, s[24:27], s21 offen offset:2048 sc1
    v_exp_f32 v179, v179
    v_exp_f32 v148, v148
    v_exp_f32 v149, v149
    v_smfmac_f32_32x32x32_bf16 v[196:211], v[144:147], v[172:179], v14
    v_exp_f32 v150, v150
    v_exp_f32 v151, v151
    v_exp_f32 v152, v152
    v_mfma_f32_32x32x8_bf16 v[164:179], v[128:129], v[118:119], 0
    v_exp_f32 v153, v153
    v_exp_f32 v154, v154
    v_exp_f32 v155, v155
    v_mfma_f32_32x32x16_bf16 v[164:179], v[120:123], v[112:115], v[164:179]
    s_waitcnt lgkmcnt(0)
    ds_read_b128 v[124:127], v10 offset:9728
    ds_read_b64 v[130:131], v12 offset:9728
    v_exp_f32 v156, v156
    v_exp_f32 v157, v157
    v_exp_f32 v158, v158
    v_smfmac_f32_32x32x32_bf16 v[180:195], v[132:135], v[148:155], v14
    s_add_u32 s4, s42, 420864
    buffer_load_dwordx4 v[252:255], v1, s[24:27], s4 offen sc1
    v_exp_f32 v159, v159
    v_exp_f32 v160, v160
    v_exp_f32 v161, v161
    s_waitcnt vmcnt(8)
    v_mfma_f32_32x32x16_bf16 v[16:31], v[216:219], v[220:223], v[16:31]
    s_add_u32 s4, s42, 557056
    buffer_load_dwordx4 v[220:223], v1, s[24:27], s4 offen sc1
    s_add_u32 s4, s42, 421888
    buffer_load_dwordx4 v[212:215], v1, s[24:27], s4 offen sc1
    v_exp_f32 v162, v162
    v_exp_f32 v163, v163
    v_exp_f32 v164, v164
    v_exp_f32 v165, v165
    v_smfmac_f32_32x32x32_bf16 v[180:195], v[136:139], v[156:163], v14
    s_waitcnt lgkmcnt(0)
    v_exp_f32 v166, v166
    v_exp_f32 v167, v167
    v_exp_f32 v168, v168
    v_mfma_f32_32x32x8_bf16 v[148:163], v[130:131], v[116:117], 0
    v_exp_f32 v169, v169
    v_exp_f32 v170, v170
    v_exp_f32 v171, v171
    v_mfma_f32_32x32x16_bf16 v[148:163], v[124:127], v[108:111], v[148:163]
    v_exp_f32 v172, v172
    v_exp_f32 v173, v173
    v_exp_f32 v174, v174
    v_smfmac_f32_32x32x32_bf16 v[196:211], v[132:135], v[164:171], v14
    ds_read_b128 v[140:143], v13 offset:8960
    ds_read_b128 v[144:147], v13 offset:9600
    v_exp_f32 v175, v175
    v_exp_f32 v176, v176
    v_exp_f32 v177, v177
    s_waitcnt vmcnt(8)
    v_mfma_f32_32x32x16_bf16 v[32:47], v[216:219], v[224:227], v[32:47]
    s_add_u32 s4, s42, 558080
    buffer_load_dwordx4 v[224:227], v1, s[24:27], s4 offen sc1
    v_exp_f32 v178, v178
    v_exp_f32 v179, v179
    s_setprio 1
    v_exp_f32 v148, v148
    v_exp_f32 v149, v149
    v_smfmac_f32_32x32x32_bf16 v[196:211], v[136:139], v[172:179], v14
    v_exp_f32 v150, v150
    v_exp_f32 v151, v151
    v_exp_f32 v152, v152
    v_mfma_f32_32x32x8_bf16 v[164:179], v[130:131], v[118:119], 0
    v_exp_f32 v153, v153
    v_exp_f32 v154, v154
    v_exp_f32 v155, v155
    v_mfma_f32_32x32x16_bf16 v[164:179], v[124:127], v[112:115], v[164:179]
    v_exp_f32 v156, v156
    v_exp_f32 v157, v157
    v_exp_f32 v158, v158
    s_waitcnt lgkmcnt(1)
    v_smfmac_f32_32x32x32_bf16 v[180:195], v[140:143], v[148:155], v14
    v_exp_f32 v159, v159
    v_exp_f32 v160, v160
    v_exp_f32 v161, v161
    s_waitcnt vmcnt(7)
    v_mfma_f32_32x32x16_bf16 v[48:63], v[216:219], v[228:231], v[48:63]
    s_add_u32 s4, s42, 559104
    buffer_load_dwordx4 v[228:231], v1, s[24:27], s4 offen sc1
    v_exp_f32 v162, v162
    v_exp_f32 v163, v163
    s_setprio 0
    v_exp_f32 v164, v164
    v_exp_f32 v165, v165
    s_waitcnt lgkmcnt(0)
    v_smfmac_f32_32x32x32_bf16 v[180:195], v[144:147], v[156:163], v14
    s_waitcnt lgkmcnt(0)
    v_exp_f32 v166, v166
    v_exp_f32 v167, v167
    v_exp_f32 v168, v168
    v_exp_f32 v169, v169
    v_exp_f32 v170, v170
    v_exp_f32 v171, v171
    v_exp_f32 v172, v172
    v_exp_f32 v173, v173
    s_waitcnt vmcnt(7)
    v_mfma_f32_32x32x16_bf16 v[64:79], v[216:219], v[232:235], v[64:79]
    s_add_u32 s4, s42, 560128
    buffer_load_dwordx4 v[232:235], v1, s[24:27], s4 offen sc1
    v_exp_f32 v174, v174
    v_exp_f32 v175, v175
    v_smfmac_f32_32x32x32_bf16 v[196:211], v[140:143], v[164:171], v14
    v_exp_f32 v176, v176
    v_exp_f32 v177, v177
    v_exp_f32 v178, v178
    s_waitcnt vmcnt(6)
    v_mfma_f32_32x32x16_bf16 v[80:95], v[216:219], v[236:239], v[80:95]
    s_add_u32 s4, s42, 561152
    buffer_load_dwordx4 v[236:239], v1, s[24:27], s4 offen sc1
    v_exp_f32 v179, v179
    s_nop 1
    v_smfmac_f32_32x32x32_bf16 v[196:211], v[144:147], v[172:179], v14
    s_branch F_pg8k
.p2align 12
F_pg8:
    s_setpc_b64 s[6:7]
F_pg8k:
    s_lshl_b32 s4, s38, 16
    s_lshl_b32 s5, s37, 12
    s_add_u32 s4, s4, s5
    s_add_u32 s5, s4, 1024
    v_add_u32 v165, s5, v1
    s_add_u32 s4, s4, 24576
    v_add_u32 v166, s4, v1
    v_add_u32 v168, s43, v1
    v_add_u32 v169, s44, v1
    v_maximum3_f32 v164, |v180|, |v181|, |v182|
    v_maximum3_f32 v164, v164, |v183|, |v184|
    v_maximum3_f32 v164, v164, |v185|, |v186|
    v_maximum3_f32 v164, v164, |v187|, |v188|
    v_maximum3_f32 v164, v164, |v189|, |v190|
    v_maximum3_f32 v164, v164, |v191|, |v192|
    v_mov_b32 v167, 159744
    s_add_u32 s6, s53, 4096
    ds_write_b128 v165, v[196:199] offset:0
    ds_write_b128 v165, v[200:203] offset:1024
    ds_write_b128 v165, v[204:207] offset:2048
    ds_write_b32 v165, v208 offset:3072
    v_maximum3_f32 v164, v164, |v196|, |v197|
    v_maximum3_f32 v164, v164, |v198|, |v199|
    v_maximum3_f32 v164, v164, |v200|, |v201|
    v_maximum3_f32 v164, v164, |v202|, |v203|
    v_maximum3_f32 v164, v164, |v204|, |v205|
    v_maximum3_f32 v164, v164, |v206|, |v207|
    v_maximum3_f32 v164, v164, |v208|, |v196|
    v_cmp_ngt_f32 vcc, 0x5d800000, v164
    v_xor_b32 v165, 0x10000, v165
    s_nop 3
    s_cbranch_vccz F_ok
    ds_write_b32 v167, v167
F_ok:
    s_waitcnt lgkmcnt(0)
    s_barrier
    ds_read_b32 v164, v167
    ds_read_b32 v160, v165 offset:3072
    ds_read_b128 v[148:151], v165 offset:0
    ds_read_b128 v[152:155], v165 offset:1024
    ds_read_b128 v[156:159], v165 offset:2048
    s_waitcnt lgkmcnt(4)
    v_readfirstlane_b32 s4, v164
    s_nop 0
    s_andn2_b32 s4, s4, s69
    s_cmp_lg_u32 s4, 0
    s_cbranch_scc1 F_fallback
    s_waitcnt lgkmcnt(3)
    v_add_f32 v192, v192, v160
    s_waitcnt lgkmcnt(2)
    v_pk_add_f32 v[180:181], v[180:181], v[148:149]
    v_pk_add_f32 v[182:183], v[182:183], v[150:151]
    v_rcp_f32 v164, v192
    s_waitcnt lgkmcnt(1)
    v_pk_add_f32 v[184:185], v[184:185], v[152:153]
    v_pk_add_f32 v[186:187], v[186:187], v[154:155]
    s_waitcnt lgkmcnt(0)
    v_pk_add_f32 v[188:189], v[188:189], v[156:157]
    v_pk_add_f32 v[190:191], v[190:191], v[158:159]
    v_pk_mul_f32 v[180:181], v[180:181], v[164:165] op_sel_hi:[1,0]
    v_pk_mul_f32 v[182:183], v[182:183], v[164:165] op_sel_hi:[1,0]
    v_pk_mul_f32 v[184:185], v[184:185], v[164:165] op_sel_hi:[1,0]
    v_pk_mul_f32 v[186:187], v[186:187], v[164:165] op_sel_hi:[1,0]
    v_pk_mul_f32 v[188:189], v[188:189], v[164:165] op_sel_hi:[1,0]
    v_pk_mul_f32 v[190:191], v[190:191], v[164:165] op_sel_hi:[1,0]
    v_cvt_pk_bf16_f32 v148, v180, v181
    v_cvt_pk_bf16_f32 v149, v182, v183
    v_cvt_pk_bf16_f32 v150, v184, v185
    v_cvt_pk_bf16_f32 v151, v186, v187
    v_cvt_pk_bf16_f32 v152, v188, v189
    v_cvt_pk_bf16_f32 v153, v190, v191
    v_min_u32 v148, -2, v148
    v_min_u32 v149, -2, v149
    v_min_u32 v150, -2, v150
    v_min_u32 v151, -2, v151
    v_min_u32 v152, -2, v152
    v_min_u32 v153, -2, v153
    buffer_store_dwordx4 v[148:151], v1, s[24:27], s49 offen sc0 sc1
    s_mov_b64 exec, s[14:15]
    buffer_store_dwordx2 v[152:153], v1, s[24:27], s50 offen sc0 sc1
    s_mov_b64 exec, -1
    s_waitcnt vmcnt(23)
    ds_read_b128 v[108:111], v168 offset:0
    ds_read_b128 v[120:123], v169 offset:0
    ds_read_b128 v[112:115], v168 offset:1024
    ds_read_b128 v[124:127], v169 offset:1024
    ds_read_b128 v[116:119], v168 offset:2048
    ds_read_b128 v[128:131], v169 offset:2048
    ds_read_b128 v[132:135], v166 offset:0
    ds_read_b128 v[136:139], v166 offset:1024
    ds_read_b128 v[140:143], v166 offset:2048
    ds_read_b128 v[144:147], v166 offset:3072
    s_mov_b32 s54, s6
    v_lshrrev_b32 v170, 1, v0
    v_lshlrev_b32 v170, 9, v170
    v_and_b32 v171, 1, v0
    v_lshl_add_u32 v170, v171, 3, v170
    s_lshl_b32 s4, s36, 6
    v_add_u32 v167, s4, v0
    s_lshl_b32 s5, s23, 5
    s_mul_i32 s6, s100, 320
    s_mov_b32 s28, s70
    s_and_b32 s29, s71, 0xffff
    s_mov_b32 s30, 2621440
    s_mov_b32 s31, 0x00020000
    v_and_b32 v168, 15, v0
    v_lshlrev_b32 v168, 4, v168
    v_bfe_u32 v169, v0, 3, 1
    v_lshl_add_u32 v169, v169, 2, s5
    v_and_b32 v172, 7, v0
    v_lshlrev_b32 v172, 3, v172
    v_lshrrev_b32 v165, 4, v167
    v_mul_u32_u24 v164, 205, v165
    v_lshrrev_b32 v164, 10, v164
    v_mul_u32_u24 v166, 5, v164
    v_sub_u32 v165, v165, v166
    v_lshlrev_b32 v173, 15, v165
    v_lshl_add_u32 v173, v164, 8, v173
    v_add_u32 v173, v168, v173
    v_lshrrev_b32 v166, 2, v164
    v_and_b32 v164, 3, v164
    v_lshl_add_u32 v164, v166, 3, v164
    v_add_u32 v164, v169, v164
    v_mul_u32_u24 v176, 1280, v164
    v_lshl_add_u32 v165, v165, 6, 64
    v_subrev_u32 v166, 320, v165
    v_min_u32 v165, v165, v166
    v_add3_u32 v176, v176, v165, s6
    v_add_u32 v176, v176, v172
    v_add_u32 v167, 512, v167
    v_lshrrev_b32 v165, 4, v167
    v_mul_u32_u24 v164, 205, v165
    v_lshrrev_b32 v164, 10, v164
    v_mul_u32_u24 v166, 5, v164
    v_sub_u32 v165, v165, v166
    v_lshlrev_b32 v174, 15, v165
    v_lshl_add_u32 v174, v164, 8, v174
    v_add_u32 v174, v168, v174
    v_lshrrev_b32 v166, 2, v164
    v_and_b32 v164, 3, v164
    v_lshl_add_u32 v164, v166, 3, v164
    v_add_u32 v164, v169, v164
    v_mul_u32_u24 v177, 1280, v164
    v_lshl_add_u32 v165, v165, 6, 64
    v_subrev_u32 v166, 320, v165
    v_min_u32 v165, v165, v166
    v_add3_u32 v177, v177, v165, s6
    v_add_u32 v177, v177, v172
    v_add_u32 v167, 512, v167
    s_cmp_lt_u32 s36, 4
    s_cselect_b32 s6, s6, 1073741824
    v_lshrrev_b32 v165, 4, v167
    v_mul_u32_u24 v164, 205, v165
    v_lshrrev_b32 v164, 10, v164
    v_mul_u32_u24 v166, 5, v164
    v_sub_u32 v165, v165, v166
    v_lshlrev_b32 v175, 15, v165
    v_lshl_add_u32 v175, v164, 8, v175
    v_add_u32 v175, v168, v175
    v_lshrrev_b32 v166, 2, v164
    v_and_b32 v164, 3, v164
    v_lshl_add_u32 v164, v166, 3, v164
    v_add_u32 v164, v169, v164
    v_mul_u32_u24 v178, 1280, v164
    v_lshl_add_u32 v165, v165, 6, 64
    v_subrev_u32 v166, 320, v165
    v_min_u32 v165, v165, v166
    v_add3_u32 v178, v178, v165, s6
    v_add_u32 v178, v178, v172
    s_lshl_b32 s4, s36, 12
    s_mov_b32 m0, s4
    s_add_u32 s43, s4, 36612
    s_add_u32 s4, s4, 131072
    v_lshl_add_u32 v172, v0, 2, s4
    s_waitcnt vmcnt(0)
    buffer_load_dwordx4 v[180:183], v1, s[24:27], s53 offen offset:0 sc1
    buffer_load_dwordx4 v[184:187], v1, s[24:27], s53 offen offset:1024 sc1
    buffer_load_dwordx4 v[188:191], v1, s[24:27], s53 offen offset:2048 sc1
    buffer_load_dwordx4 v[192:195], v1, s[24:27], s53 offen offset:3072 sc1
    buffer_load_dwordx4 v[196:199], v1, s[24:27], s54 offen sc1
    s_waitcnt lgkmcnt(0)
    s_barrier
    s_waitcnt vmcnt(4)
    v_max_u32 v164, v180, v181
    v_max3_u32 v164, v164, v182, v183
    s_waitcnt vmcnt(3)
    v_max3_u32 v164, v164, v184, v185
    v_max3_u32 v164, v164, v186, v187
    s_waitcnt vmcnt(2)
    v_max3_u32 v164, v164, v188, v189
    v_max3_u32 v164, v164, v190, v191
    s_waitcnt vmcnt(1)
    v_max3_u32 v164, v164, v192, v193
    v_max3_u32 v164, v164, v194, v195
    s_waitcnt vmcnt(0)
    v_max3_u32 v164, v164, v196, v197
    v_max3_u32 v164, v164, v198, v199
    v_cmp_eq_u32 vcc, -1, v164
    s_nop 4
    s_cbranch_vccnz F_s3
F_s3k:
    buffer_load_dwordx2 v[152:153], v176, s[8:11], 0 offen
    buffer_load_dwordx2 v[156:157], v177, s[8:11], 0 offen
    buffer_load_dwordx2 v[160:161], v178, s[8:11], 0 offen
    v_mfma_f32_32x32x16_bf16 v[16:31], v[180:183], v[108:111], v[16:31]
    v_mfma_f32_32x32x16_bf16 v[16:31], v[184:187], v[112:115], v[16:31]
    v_mfma_f32_32x32x16_bf16 v[16:31], v[188:191], v[116:119], v[16:31]
    v_mfma_f32_32x32x16_bf16 v[16:31], v[192:195], v[2:5], v[16:31]
    v_mfma_f32_32x32x16_bf16 v[16:31], v[196:199], v[6:9], v[16:31]
    v_mfma_f32_32x32x16_bf16 v[32:47], v[180:183], v[120:123], v[32:47]
    v_mfma_f32_32x32x16_bf16 v[32:47], v[184:187], v[124:127], v[32:47]
    s_nop 9
    ds_write2st64_b32 v172, v16, v17 offset0:0 offset1:1
    ds_write2st64_b32 v172, v18, v19 offset0:2 offset1:3
    v_mfma_f32_32x32x16_bf16 v[32:47], v[188:191], v[128:131], v[32:47]
    ds_write2st64_b32 v172, v20, v21 offset0:4 offset1:5
    ds_write2st64_b32 v172, v22, v23 offset0:6 offset1:7
    v_mfma_f32_32x32x16_bf16 v[32:47], v[192:195], v[96:99], v[32:47]
    ds_write2st64_b32 v172, v24, v25 offset0:8 offset1:9
    ds_write2st64_b32 v172, v26, v27 offset0:10 offset1:11
    v_mfma_f32_32x32x16_bf16 v[32:47], v[196:199], v[100:103], v[32:47]
    ds_write2st64_b32 v172, v28, v29 offset0:12 offset1:13
    ds_write2st64_b32 v172, v30, v31 offset0:14 offset1:15
    v_mfma_f32_32x32x16_bf16 v[48:63], v[180:183], v[132:135], v[48:63]
    v_mfma_f32_32x32x16_bf16 v[48:63], v[184:187], v[136:139], v[48:63]
    s_nop 7
    ds_write_addtid_b32 v32 offset:0
    ds_write_addtid_b32 v33 offset:256
    ds_write_addtid_b32 v34 offset:512
    ds_write_addtid_b32 v35 offset:768
    v_mfma_f32_32x32x16_bf16 v[48:63], v[188:191], v[140:143], v[48:63]
    ds_write_addtid_b32 v36 offset:1024
    ds_write_addtid_b32 v37 offset:1280
    ds_write_addtid_b32 v38 offset:1536
    ds_write_addtid_b32 v39 offset:1792
    v_mfma_f32_32x32x16_bf16 v[48:63], v[192:195], v[144:147], v[48:63]
    ds_write_addtid_b32 v40 offset:2048
    ds_write_addtid_b32 v41 offset:2304
    ds_write_addtid_b32 v42 offset:2560
    ds_write_addtid_b32 v43 offset:2816
    v_mfma_f32_32x32x16_bf16 v[48:63], v[196:199], v[104:107], v[48:63]
    ds_write_addtid_b32 v44 offset:3072
    ds_write_addtid_b32 v45 offset:3328
    ds_write_addtid_b32 v46 offset:3584
    ds_write_addtid_b32 v47 offset:3840
    v_mfma_f32_32x32x16_bf16 v[64:79], v[180:183], v[240:243], v[64:79]
    v_mfma_f32_32x32x16_bf16 v[64:79], v[184:187], v[244:247], v[64:79]
    s_nop 5
    ds_write_addtid_b32 v48 offset:32768
    ds_write_addtid_b32 v49 offset:33024
    ds_write_addtid_b32 v50 offset:33280
    ds_write_addtid_b32 v51 offset:33536
    v_mfma_f32_32x32x16_bf16 v[64:79], v[188:191], v[248:251], v[64:79]
    ds_write_addtid_b32 v52 offset:33792
    ds_write_addtid_b32 v53 offset:34048
    ds_write_addtid_b32 v54 offset:34304
    ds_write_addtid_b32 v55 offset:34560
    v_mfma_f32_32x32x16_bf16 v[64:79], v[192:195], v[252:255], v[64:79]
    ds_write_addtid_b32 v56 offset:34816
    ds_write_addtid_b32 v57 offset:35072
    ds_write_addtid_b32 v58 offset:35328
    ds_write_addtid_b32 v59 offset:35584
    v_mfma_f32_32x32x16_bf16 v[64:79], v[196:199], v[212:215], v[64:79]
    ds_write_addtid_b32 v60 offset:35840
    ds_write_addtid_b32 v61 offset:36096
    ds_write_addtid_b32 v62 offset:36352
    ds_write_addtid_b32 v63 offset:36608
    v_mfma_f32_32x32x16_bf16 v[80:95], v[180:183], v[220:223], v[80:95]
    v_mfma_f32_32x32x16_bf16 v[80:95], v[184:187], v[224:227], v[80:95]
    s_mov_b32 m0, s43
    s_nop 0
    s_nop 3
    ds_write_addtid_b32 v64 offset:28924
    ds_write_addtid_b32 v65 offset:29180
    ds_write_addtid_b32 v66 offset:29436
    ds_write_addtid_b32 v67 offset:29692
    v_mfma_f32_32x32x16_bf16 v[80:95], v[188:191], v[228:231], v[80:95]
    ds_write_addtid_b32 v68 offset:29948
    ds_write_addtid_b32 v69 offset:30204
    ds_write_addtid_b32 v70 offset:30460
    ds_write_addtid_b32 v71 offset:30716
    v_mfma_f32_32x32x16_bf16 v[80:95], v[192:195], v[232:235], v[80:95]
    ds_write_addtid_b32 v72 offset:30972
    ds_write_addtid_b32 v73 offset:31228
    ds_write_addtid_b32 v74 offset:31484
    ds_write_addtid_b32 v75 offset:31740
    v_mfma_f32_32x32x16_bf16 v[80:95], v[196:199], v[236:239], v[80:95]
    ds_write_addtid_b32 v76 offset:31996
    ds_write_addtid_b32 v77 offset:32252
    ds_write_addtid_b32 v78 offset:32508
    ds_write_addtid_b32 v79 offset:32764
    s_nop 7
    ds_write_addtid_b32 v80 offset:61692
    ds_write_addtid_b32 v81 offset:61948
    ds_write_addtid_b32 v82 offset:62204
    ds_write_addtid_b32 v83 offset:62460
    ds_write_addtid_b32 v84 offset:62716
    ds_write_addtid_b32 v85 offset:62972
    ds_write_addtid_b32 v86 offset:63228
    ds_write_addtid_b32 v87 offset:63484
    ds_write_addtid_b32 v88 offset:63740
    ds_write_addtid_b32 v89 offset:63996
    ds_write_addtid_b32 v90 offset:64252
    ds_write_addtid_b32 v91 offset:64508
    ds_write_addtid_b32 v92 offset:64764
    ds_write_addtid_b32 v93 offset:65020
    ds_write_addtid_b32 v94 offset:65276
    ds_write_addtid_b32 v95 offset:65532
    s_waitcnt lgkmcnt(0)
    s_barrier
    ds_read_b128 v[16:19], v173 offset:0
    ds_read_b128 v[20:23], v173 offset:4096
    ds_read_b128 v[24:27], v173 offset:8192
    ds_read_b128 v[28:31], v173 offset:12288
    ds_read_b128 v[32:35], v173 offset:16384
    ds_read_b128 v[36:39], v173 offset:20480
    ds_read_b128 v[40:43], v173 offset:24576
    ds_read_b128 v[44:47], v173 offset:28672
    ds_read_b128 v[48:51], v174 offset:0
    ds_read_b128 v[52:55], v174 offset:4096
    ds_read_b128 v[56:59], v174 offset:8192
    ds_read_b128 v[60:63], v174 offset:12288
    ds_read_b128 v[64:67], v174 offset:16384
    ds_read_b128 v[68:71], v174 offset:20480
    ds_read_b128 v[72:75], v174 offset:24576
    ds_read_b128 v[76:79], v174 offset:28672
    s_cmp_ge_u32 s36, 4
    s_cbranch_scc1 F_two
    ds_read_b128 v[80:83], v175 offset:0
    ds_read_b128 v[84:87], v175 offset:4096
    ds_read_b128 v[88:91], v175 offset:8192
    ds_read_b128 v[92:95], v175 offset:12288
    ds_read_b128 v[96:99], v175 offset:16384
    ds_read_b128 v[100:103], v175 offset:20480
    ds_read_b128 v[104:107], v175 offset:24576
    ds_read_b128 v[108:111], v175 offset:28672
    s_waitcnt lgkmcnt(15)
    v_pk_add_f32 v[16:17], v[16:17], v[20:21]
    v_pk_add_f32 v[18:19], v[18:19], v[22:23]
    v_pk_add_f32 v[24:25], v[24:25], v[28:29]
    v_pk_add_f32 v[26:27], v[26:27], v[30:31]
    v_pk_add_f32 v[32:33], v[32:33], v[36:37]
    v_pk_add_f32 v[34:35], v[34:35], v[38:39]
    v_pk_add_f32 v[40:41], v[40:41], v[44:45]
    v_pk_add_f32 v[42:43], v[42:43], v[46:47]
    v_pk_add_f32 v[16:17], v[16:17], v[24:25]
    v_pk_add_f32 v[18:19], v[18:19], v[26:27]
    v_pk_add_f32 v[32:33], v[32:33], v[40:41]
    v_pk_add_f32 v[34:35], v[34:35], v[42:43]
    v_pk_add_f32 v[16:17], v[16:17], v[32:33]
    v_pk_add_f32 v[18:19], v[18:19], v[34:35]
    s_waitcnt vmcnt(2)
    v_lshlrev_b32 v20, 16, v152
    v_and_b32 v21, 0xffff0000, v152
    v_pk_add_f32 v[16:17], v[16:17], v[20:21]
    v_cvt_pk_bf16_f32 v152, v16, v17
    v_lshlrev_b32 v20, 16, v153
    v_and_b32 v21, 0xffff0000, v153
    v_pk_add_f32 v[18:19], v[18:19], v[20:21]
    v_cvt_pk_bf16_f32 v153, v18, v19
    buffer_store_dwordx2 v[152:153], v176, s[28:31], 0 offen sc0 sc1
    s_waitcnt lgkmcnt(14)
    v_pk_add_f32 v[48:49], v[48:49], v[52:53]
    v_pk_add_f32 v[50:51], v[50:51], v[54:55]
    s_waitcnt lgkmcnt(12)
    v_pk_add_f32 v[56:57], v[56:57], v[60:61]
    v_pk_add_f32 v[58:59], v[58:59], v[62:63]
    s_waitcnt lgkmcnt(10)
    v_pk_add_f32 v[64:65], v[64:65], v[68:69]
    v_pk_add_f32 v[66:67], v[66:67], v[70:71]
    s_waitcnt lgkmcnt(8)
    v_pk_add_f32 v[72:73], v[72:73], v[76:77]
    v_pk_add_f32 v[74:75], v[74:75], v[78:79]
    v_pk_add_f32 v[48:49], v[48:49], v[56:57]
    v_pk_add_f32 v[50:51], v[50:51], v[58:59]
    v_pk_add_f32 v[64:65], v[64:65], v[72:73]
    v_pk_add_f32 v[66:67], v[66:67], v[74:75]
    v_pk_add_f32 v[48:49], v[48:49], v[64:65]
    v_pk_add_f32 v[50:51], v[50:51], v[66:67]
    s_waitcnt vmcnt(2)
    v_lshlrev_b32 v52, 16, v156
    v_and_b32 v53, 0xffff0000, v156
    v_pk_add_f32 v[48:49], v[48:49], v[52:53]
    v_cvt_pk_bf16_f32 v156, v48, v49
    v_lshlrev_b32 v52, 16, v157
    v_and_b32 v53, 0xffff0000, v157
    v_pk_add_f32 v[50:51], v[50:51], v[52:53]
    v_cvt_pk_bf16_f32 v157, v50, v51
    buffer_store_dwordx2 v[156:157], v177, s[28:31], 0 offen sc0 sc1
    s_waitcnt lgkmcnt(6)
    v_pk_add_f32 v[80:81], v[80:81], v[84:85]
    v_pk_add_f32 v[82:83], v[82:83], v[86:87]
    s_waitcnt lgkmcnt(4)
    v_pk_add_f32 v[88:89], v[88:89], v[92:93]
    v_pk_add_f32 v[90:91], v[90:91], v[94:95]
    s_waitcnt lgkmcnt(2)
    v_pk_add_f32 v[96:97], v[96:97], v[100:101]
    v_pk_add_f32 v[98:99], v[98:99], v[102:103]
    s_waitcnt lgkmcnt(0)
    v_pk_add_f32 v[104:105], v[104:105], v[108:109]
    v_pk_add_f32 v[106:107], v[106:107], v[110:111]
    v_pk_add_f32 v[80:81], v[80:81], v[88:89]
    v_pk_add_f32 v[82:83], v[82:83], v[90:91]
    v_pk_add_f32 v[96:97], v[96:97], v[104:105]
    v_pk_add_f32 v[98:99], v[98:99], v[106:107]
    v_pk_add_f32 v[80:81], v[80:81], v[96:97]
    v_pk_add_f32 v[82:83], v[82:83], v[98:99]
    s_waitcnt vmcnt(2)
    v_lshlrev_b32 v84, 16, v160
    v_and_b32 v85, 0xffff0000, v160
    v_pk_add_f32 v[80:81], v[80:81], v[84:85]
    v_cvt_pk_bf16_f32 v160, v80, v81
    v_lshlrev_b32 v84, 16, v161
    v_and_b32 v85, 0xffff0000, v161
    v_pk_add_f32 v[82:83], v[82:83], v[84:85]
    v_cvt_pk_bf16_f32 v161, v82, v83
    buffer_store_dwordx2 v[160:161], v178, s[28:31], 0 offen sc0 sc1
    s_endpgm
F_two:
    s_waitcnt vmcnt(0) lgkmcnt(0)
    v_pk_add_f32 v[16:17], v[16:17], v[20:21]
    v_pk_add_f32 v[18:19], v[18:19], v[22:23]
    v_pk_add_f32 v[24:25], v[24:25], v[28:29]
    v_pk_add_f32 v[26:27], v[26:27], v[30:31]
    v_pk_add_f32 v[32:33], v[32:33], v[36:37]
    v_pk_add_f32 v[34:35], v[34:35], v[38:39]
    v_pk_add_f32 v[40:41], v[40:41], v[44:45]
    v_pk_add_f32 v[42:43], v[42:43], v[46:47]
    v_pk_add_f32 v[16:17], v[16:17], v[24:25]
    v_pk_add_f32 v[18:19], v[18:19], v[26:27]
    v_pk_add_f32 v[32:33], v[32:33], v[40:41]
    v_pk_add_f32 v[34:35], v[34:35], v[42:43]
    v_pk_add_f32 v[16:17], v[16:17], v[32:33]
    v_pk_add_f32 v[18:19], v[18:19], v[34:35]
    v_lshlrev_b32 v20, 16, v152
    v_and_b32 v21, 0xffff0000, v152
    v_pk_add_f32 v[16:17], v[16:17], v[20:21]
    v_cvt_pk_bf16_f32 v152, v16, v17
    v_lshlrev_b32 v20, 16, v153
    v_and_b32 v21, 0xffff0000, v153
    v_pk_add_f32 v[18:19], v[18:19], v[20:21]
    v_cvt_pk_bf16_f32 v153, v18, v19
    buffer_store_dwordx2 v[152:153], v176, s[28:31], 0 offen sc0 sc1
    v_pk_add_f32 v[48:49], v[48:49], v[52:53]
    v_pk_add_f32 v[50:51], v[50:51], v[54:55]
    v_pk_add_f32 v[56:57], v[56:57], v[60:61]
    v_pk_add_f32 v[58:59], v[58:59], v[62:63]
    v_pk_add_f32 v[64:65], v[64:65], v[68:69]
    v_pk_add_f32 v[66:67], v[66:67], v[70:71]
    v_pk_add_f32 v[72:73], v[72:73], v[76:77]
    v_pk_add_f32 v[74:75], v[74:75], v[78:79]
    v_pk_add_f32 v[48:49], v[48:49], v[56:57]
    v_pk_add_f32 v[50:51], v[50:51], v[58:59]
    v_pk_add_f32 v[64:65], v[64:65], v[72:73]
    v_pk_add_f32 v[66:67], v[66:67], v[74:75]
    v_pk_add_f32 v[48:49], v[48:49], v[64:65]
    v_pk_add_f32 v[50:51], v[50:51], v[66:67]
    v_lshlrev_b32 v52, 16, v156
    v_and_b32 v53, 0xffff0000, v156
    v_pk_add_f32 v[48:49], v[48:49], v[52:53]
    v_cvt_pk_bf16_f32 v156, v48, v49
    v_lshlrev_b32 v52, 16, v157
    v_and_b32 v53, 0xffff0000, v157
    v_pk_add_f32 v[50:51], v[50:51], v[52:53]
    v_cvt_pk_bf16_f32 v157, v50, v51
    buffer_store_dwordx2 v[156:157], v177, s[28:31], 0 offen sc0 sc1
    s_endpgm
F_fallback:
    s_waitcnt vmcnt(0) lgkmcnt(0)
    s_mov_b32 s69, -1
    s_lshl_b32 s4, s57, 8
    s_lshl_b32 s5, s37, 6
    s_add_u32 s4, s4, s5
    s_lshl_b32 s5, s38, 5
    s_add_u32 s4, s4, s5
    v_and_b32 v100, 31, v0
    v_add_u32 v100, s4, v100
    v_lshlrev_b32 v100, 4, v100
    v_lshrrev_b32 v102, 5, v0
    v_lshl_add_u32 v101, v102, 30, v100
    v_lshl_add_u32 v100, v102, 15, v100
    s_lshl_b32 s4, s58, 15
    buffer_load_dwordx4 v[108:111], v100, s[24:27], s4 offen sc1
    v_xor_b32 v100, 512, v100
    buffer_load_dwordx4 v[112:115], v100, s[24:27], s4 offen sc1
    s_lshl_b32 s4, s59, 15
    s_lshl_b32 s5, s60, 3
    s_add_u32 s4, s4, s5
    buffer_load_dwordx2 v[116:117], v101, s[24:27], s4 offen sc1
    v_xor_b32 v101, 512, v101
    buffer_load_dwordx2 v[118:119], v101, s[24:27], s4 offen sc1
    s_add_u32 s62, s58, 80
    s_lshl_b32 s62, s62, 15
    s_mul_i32 s4, s38, 12288
    s_add_u32 s62, s62, s4
    s_add_u32 s62, s62, s55
    s_mul_i32 s63, s56, 81920
    s_mul_i32 s4, s38, 40960
    s_add_u32 s63, s63, s4
    s_mul_i32 s4, s37, 2560
    s_add_u32 s63, s63, s4
    s_add_u32 s63, s63, 5242880
    s_mov_b32 s67, 0
    s_lshl_b32 s5, s38, 16
    s_add_u32 s5, s5, 24576
    s_mul_i32 s4, s37, 3072
    s_add_u32 s64, s5, s4
    s_lshl_b32 s5, s38, 16
    s_mul_i32 s4, s37, 2560
    s_add_u32 s65, s5, s4
    s_add_u32 s65, s65, 36864
    v_and_b32 v102, 0x13, v0
    v_bfe_u32 v103, v0, 2, 1
    v_lshl_add_u32 v102, v103, 3, v102
    v_bfe_u32 v103, v0, 3, 1
    v_lshl_add_u32 v102, v103, 2, v102
    v_lshlrev_b32 v102, 4, v102
    v_lshrrev_b32 v103, 5, v0
    v_lshl_add_u32 v10, v103, 10, v102
    v_mul_u32_u24 v13, 320, v103
    v_and_b32 v103, 31, v0
    v_lshl_add_u32 v13, v103, 4, v13
    s_lshl_b32 s4, s38, 16
    s_add_u32 s4, s4, 24576
    v_add_u32 v10, s4, v10
    s_add_u32 s4, s4, 12288
    v_add_u32 v13, s4, v13
    s_lshl_b32 s4, s38, 16
    s_lshl_b32 s5, s60, 3
    s_add_u32 s5, s5, s4
    s_add_u32 s5, s5, 26624
    v_add_u32 v12, s5, v102
    v_mov_b32 v102, 149536
    v_mov_b32 v103, 149504
    s_mov_b32 s4, 0x11000000
    s_mov_b32 s5, s4
    v_cndmask_b32 v102, v102, v103, s[4:5]
    v_cndmask_b32 v13, v102, v13, s[12:13]
    v_mov_b32 v102, 149520
    v_cndmask_b32 v12, v102, v12, s[14:15]
    v_mov_b32 v14, 0xdddddddd
    v_mov_b32 v106, 0xff800000
    v_mov_b32 v107, 0xff800000
    s_mov_b32 s66, 0
F_fb_loop:
    s_barrier
    s_add_u32 m0, s64, s67
    s_nop 0
    buffer_load_dwordx4 v1, s[24:27], s62 offen sc1 lds
    s_add_u32 m0, m0, 1024
    s_add_u32 s4, s62, 32768
    buffer_load_dwordx4 v1, s[24:27], s4 offen sc1 lds
    s_add_u32 m0, m0, 1024
    s_add_u32 s4, s62, s61
    buffer_load_dwordx4 v1, s[24:27], s4 offen sc1 lds
    s_add_u32 s62, s62, 4096
    s_waitcnt vmcnt(0)
    s_barrier
    ds_read_b128 v[120:123], v10 offset:0
    ds_read_b64 v[128:129], v12 offset:0
    s_waitcnt lgkmcnt(0)
    v_mfma_f32_32x32x8_bf16 v[148:163], v[128:129], v[116:117], 0
    v_mfma_f32_32x32x16_bf16 v[148:163], v[120:123], v[108:111], v[148:163]
    v_mfma_f32_32x32x8_bf16 v[164:179], v[128:129], v[118:119], 0
    v_mfma_f32_32x32x16_bf16 v[164:179], v[120:123], v[112:115], v[164:179]
    s_nop 9
    v_max3_f32 v106, v148, v149, v106
    v_max3_f32 v106, v106, v150, v151
    v_max3_f32 v106, v106, v152, v153
    v_max3_f32 v106, v106, v154, v155
    v_max3_f32 v106, v106, v156, v157
    v_max3_f32 v106, v106, v158, v159
    v_max3_f32 v106, v106, v160, v161
    v_max3_f32 v106, v106, v162, v163
    v_max3_f32 v107, v164, v165, v107
    v_max3_f32 v107, v107, v166, v167
    v_max3_f32 v107, v107, v168, v169
    v_max3_f32 v107, v107, v170, v171
    v_max3_f32 v107, v107, v172, v173
    v_max3_f32 v107, v107, v174, v175
    v_max3_f32 v107, v107, v176, v177
    v_max3_f32 v107, v107, v178, v179
    ds_read_b128 v[120:123], v10 offset:512
    ds_read_b64 v[128:129], v12 offset:512
    s_waitcnt lgkmcnt(0)
    v_mfma_f32_32x32x8_bf16 v[148:163], v[128:129], v[116:117], 0
    v_mfma_f32_32x32x16_bf16 v[148:163], v[120:123], v[108:111], v[148:163]
    v_mfma_f32_32x32x8_bf16 v[164:179], v[128:129], v[118:119], 0
    v_mfma_f32_32x32x16_bf16 v[164:179], v[120:123], v[112:115], v[164:179]
    s_nop 9
    v_max3_f32 v106, v148, v149, v106
    v_max3_f32 v106, v106, v150, v151
    v_max3_f32 v106, v106, v152, v153
    v_max3_f32 v106, v106, v154, v155
    v_max3_f32 v106, v106, v156, v157
    v_max3_f32 v106, v106, v158, v159
    v_max3_f32 v106, v106, v160, v161
    v_max3_f32 v106, v106, v162, v163
    v_max3_f32 v107, v164, v165, v107
    v_max3_f32 v107, v107, v166, v167
    v_max3_f32 v107, v107, v168, v169
    v_max3_f32 v107, v107, v170, v171
    v_max3_f32 v107, v107, v172, v173
    v_max3_f32 v107, v107, v174, v175
    v_max3_f32 v107, v107, v176, v177
    v_max3_f32 v107, v107, v178, v179
    ds_read_b128 v[120:123], v10 offset:3072
    ds_read_b64 v[128:129], v12 offset:3072
    s_waitcnt lgkmcnt(0)
    v_mfma_f32_32x32x8_bf16 v[148:163], v[128:129], v[116:117], 0
    v_mfma_f32_32x32x16_bf16 v[148:163], v[120:123], v[108:111], v[148:163]
    v_mfma_f32_32x32x8_bf16 v[164:179], v[128:129], v[118:119], 0
    v_mfma_f32_32x32x16_bf16 v[164:179], v[120:123], v[112:115], v[164:179]
    s_nop 9
    v_max3_f32 v106, v148, v149, v106
    v_max3_f32 v106, v106, v150, v151
    v_max3_f32 v106, v106, v152, v153
    v_max3_f32 v106, v106, v154, v155
    v_max3_f32 v106, v106, v156, v157
    v_max3_f32 v106, v106, v158, v159
    v_max3_f32 v106, v106, v160, v161
    v_max3_f32 v106, v106, v162, v163
    v_max3_f32 v107, v164, v165, v107
    v_max3_f32 v107, v107, v166, v167
    v_max3_f32 v107, v107, v168, v169
    v_max3_f32 v107, v107, v170, v171
    v_max3_f32 v107, v107, v172, v173
    v_max3_f32 v107, v107, v174, v175
    v_max3_f32 v107, v107, v176, v177
    v_max3_f32 v107, v107, v178, v179
    ds_read_b128 v[120:123], v10 offset:3584
    ds_read_b64 v[128:129], v12 offset:3584
    s_waitcnt lgkmcnt(0)
    v_mfma_f32_32x32x8_bf16 v[148:163], v[128:129], v[116:117], 0
    v_mfma_f32_32x32x16_bf16 v[148:163], v[120:123], v[108:111], v[148:163]
    v_mfma_f32_32x32x8_bf16 v[164:179], v[128:129], v[118:119], 0
    v_mfma_f32_32x32x16_bf16 v[164:179], v[120:123], v[112:115], v[164:179]
    s_nop 9
    v_max3_f32 v106, v148, v149, v106
    v_max3_f32 v106, v106, v150, v151
    v_max3_f32 v106, v106, v152, v153
    v_max3_f32 v106, v106, v154, v155
    v_max3_f32 v106, v106, v156, v157
    v_max3_f32 v106, v106, v158, v159
    v_max3_f32 v106, v106, v160, v161
    v_max3_f32 v106, v106, v162, v163
    v_max3_f32 v107, v164, v165, v107
    v_max3_f32 v107, v107, v166, v167
    v_max3_f32 v107, v107, v168, v169
    v_max3_f32 v107, v107, v170, v171
    v_max3_f32 v107, v107, v172, v173
    v_max3_f32 v107, v107, v174, v175
    v_max3_f32 v107, v107, v176, v177
    v_max3_f32 v107, v107, v178, v179
    ds_read_b128 v[120:123], v10 offset:6144
    ds_read_b64 v[128:129], v12 offset:6144
    s_waitcnt lgkmcnt(0)
    v_mfma_f32_32x32x8_bf16 v[148:163], v[128:129], v[116:117], 0
    v_mfma_f32_32x32x16_bf16 v[148:163], v[120:123], v[108:111], v[148:163]
    v_mfma_f32_32x32x8_bf16 v[164:179], v[128:129], v[118:119], 0
    v_mfma_f32_32x32x16_bf16 v[164:179], v[120:123], v[112:115], v[164:179]
    s_nop 9
    v_max3_f32 v106, v148, v149, v106
    v_max3_f32 v106, v106, v150, v151
    v_max3_f32 v106, v106, v152, v153
    v_max3_f32 v106, v106, v154, v155
    v_max3_f32 v106, v106, v156, v157
    v_max3_f32 v106, v106, v158, v159
    v_max3_f32 v106, v106, v160, v161
    v_max3_f32 v106, v106, v162, v163
    v_max3_f32 v107, v164, v165, v107
    v_max3_f32 v107, v107, v166, v167
    v_max3_f32 v107, v107, v168, v169
    v_max3_f32 v107, v107, v170, v171
    v_max3_f32 v107, v107, v172, v173
    v_max3_f32 v107, v107, v174, v175
    v_max3_f32 v107, v107, v176, v177
    v_max3_f32 v107, v107, v178, v179
    ds_read_b128 v[120:123], v10 offset:6656
    ds_read_b64 v[128:129], v12 offset:6656
    s_waitcnt lgkmcnt(0)
    v_mfma_f32_32x32x8_bf16 v[148:163], v[128:129], v[116:117], 0
    v_mfma_f32_32x32x16_bf16 v[148:163], v[120:123], v[108:111], v[148:163]
    v_mfma_f32_32x32x8_bf16 v[164:179], v[128:129], v[118:119], 0
    v_mfma_f32_32x32x16_bf16 v[164:179], v[120:123], v[112:115], v[164:179]
    s_nop 9
    v_max3_f32 v106, v148, v149, v106
    v_max3_f32 v106, v106, v150, v151
    v_max3_f32 v106, v106, v152, v153
    v_max3_f32 v106, v106, v154, v155
    v_max3_f32 v106, v106, v156, v157
    v_max3_f32 v106, v106, v158, v159
    v_max3_f32 v106, v106, v160, v161
    v_max3_f32 v106, v106, v162, v163
    v_max3_f32 v107, v164, v165, v107
    v_max3_f32 v107, v107, v166, v167
    v_max3_f32 v107, v107, v168, v169
    v_max3_f32 v107, v107, v170, v171
    v_max3_f32 v107, v107, v172, v173
    v_max3_f32 v107, v107, v174, v175
    v_max3_f32 v107, v107, v176, v177
    v_max3_f32 v107, v107, v178, v179
    ds_read_b128 v[120:123], v10 offset:9216
    ds_read_b64 v[128:129], v12 offset:9216
    s_waitcnt lgkmcnt(0)
    v_mfma_f32_32x32x8_bf16 v[148:163], v[128:129], v[116:117], 0
    v_mfma_f32_32x32x16_bf16 v[148:163], v[120:123], v[108:111], v[148:163]
    v_mfma_f32_32x32x8_bf16 v[164:179], v[128:129], v[118:119], 0
    v_mfma_f32_32x32x16_bf16 v[164:179], v[120:123], v[112:115], v[164:179]
    s_nop 9
    v_max3_f32 v106, v148, v149, v106
    v_max3_f32 v106, v106, v150, v151
    v_max3_f32 v106, v106, v152, v153
    v_max3_f32 v106, v106, v154, v155
    v_max3_f32 v106, v106, v156, v157
    v_max3_f32 v106, v106, v158, v159
    v_max3_f32 v106, v106, v160, v161
    v_max3_f32 v106, v106, v162, v163
    v_max3_f32 v107, v164, v165, v107
    v_max3_f32 v107, v107, v166, v167
    v_max3_f32 v107, v107, v168, v169
    v_max3_f32 v107, v107, v170, v171
    v_max3_f32 v107, v107, v172, v173
    v_max3_f32 v107, v107, v174, v175
    v_max3_f32 v107, v107, v176, v177
    v_max3_f32 v107, v107, v178, v179
    ds_read_b128 v[120:123], v10 offset:9728
    ds_read_b64 v[128:129], v12 offset:9728
    s_waitcnt lgkmcnt(0)
    v_mfma_f32_32x32x8_bf16 v[148:163], v[128:129], v[116:117], 0
    v_mfma_f32_32x32x16_bf16 v[148:163], v[120:123], v[108:111], v[148:163]
    v_mfma_f32_32x32x8_bf16 v[164:179], v[128:129], v[118:119], 0
    v_mfma_f32_32x32x16_bf16 v[164:179], v[120:123], v[112:115], v[164:179]
    s_nop 9
    v_max3_f32 v106, v148, v149, v106
    v_max3_f32 v106, v106, v150, v151
    v_max3_f32 v106, v106, v152, v153
    v_max3_f32 v106, v106, v154, v155
    v_max3_f32 v106, v106, v156, v157
    v_max3_f32 v106, v106, v158, v159
    v_max3_f32 v106, v106, v160, v161
    v_max3_f32 v106, v106, v162, v163
    v_max3_f32 v107, v164, v165, v107
    v_max3_f32 v107, v107, v166, v167
    v_max3_f32 v107, v107, v168, v169
    v_max3_f32 v107, v107, v170, v171
    v_max3_f32 v107, v107, v172, v173
    v_max3_f32 v107, v107, v174, v175
    v_max3_f32 v107, v107, v176, v177
    v_max3_f32 v107, v107, v178, v179
    s_add_u32 s66, s66, 1
    s_cmp_lt_u32 s66, 4
    s_cbranch_scc1 F_fb_loop
    s_lshl_b32 s4, s36, 9
    v_lshl_add_u32 v104, v0, 2, s4
    v_xor_b32 v105, 0x800, v104
    v_add_u32 v104, 131072, v104
    v_add_u32 v105, 131072, v105
    ds_write_b32 v104, v106
    ds_write_b32 v104, v107 offset:256
    s_waitcnt lgkmcnt(0)
    s_barrier
    ds_read_b32 v102, v105 offset:256
    ds_read_b32 v103, v105
    s_waitcnt lgkmcnt(1)
    v_max_f32 v106, v106, v102
    s_waitcnt lgkmcnt(0)
    v_max_f32 v107, v107, v103
    v_mov_b32 v100, v106
    s_nop 1
    v_permlane32_swap_b32 v100, v106
    v_max_f32 v106, v100, v106
    v_sub_f32 v106, 0, v106
    v_cvt_pk_bf16_f32 v102, v106, v106
    v_lshlrev_b32 v102, 16, v102
    v_sub_f32 v102, v106, v102
    v_cvt_pk_bf16_f32 v100, v106, v102
    v_and_b32 v106, 0xffff0000, v100
    v_sub_f32 v102, v102, v106
    v_cvt_pk_bf16_f32 v101, v102, 0
    v_cndmask_b32 v116, v100, v116, s[14:15]
    v_cndmask_b32 v117, v101, v117, s[14:15]
    v_mov_b32 v100, v107
    s_nop 1
    v_permlane32_swap_b32 v100, v107
    v_max_f32 v107, v100, v107
    v_sub_f32 v107, 0, v107
    v_cvt_pk_bf16_f32 v102, v107, v107
    v_lshlrev_b32 v102, 16, v102
    v_sub_f32 v102, v107, v102
    v_cvt_pk_bf16_f32 v100, v107, v102
    v_and_b32 v107, 0xffff0000, v100
    v_sub_f32 v102, v102, v107
    v_cvt_pk_bf16_f32 v101, v102, 0
    v_cndmask_b32 v118, v100, v118, s[14:15]
    v_cndmask_b32 v119, v101, v119, s[14:15]
    s_add_u32 s62, s58, 80
    s_lshl_b32 s62, s62, 15
    s_mul_i32 s4, s38, 12288
    s_add_u32 s62, s62, s4
    s_add_u32 s62, s62, s55
    s_mul_i32 s63, s56, 81920
    s_mul_i32 s4, s38, 40960
    s_add_u32 s63, s63, s4
    s_mul_i32 s4, s37, 2560
    s_add_u32 s63, s63, s4
    s_add_u32 s63, s63, 5242880
    s_mov_b32 s67, 0
    s_add_u32 m0, s64, s67
    s_nop 0
    buffer_load_dwordx4 v1, s[24:27], s62 offen sc1 lds
    s_add_u32 m0, m0, 1024
    s_add_u32 s4, s62, 32768
    buffer_load_dwordx4 v1, s[24:27], s4 offen sc1 lds
    s_add_u32 m0, m0, 1024
    s_add_u32 s4, s62, s61
    buffer_load_dwordx4 v1, s[24:27], s4 offen sc1 lds
    s_add_u32 m0, s65, s67
    s_add_u32 s62, s62, 4096
    buffer_load_dwordx4 v1, s[24:27], s63 offen sc1 lds
    buffer_load_dwordx4 v1, s[24:27], s63 offen offset:1024 sc1 lds
    buffer_load_dwordx4 v1, s[24:27], s63 offen offset:2048 sc1 lds
    s_add_u32 s63, s63, 10240
    s_waitcnt vmcnt(0) lgkmcnt(0)
    s_barrier
    ds_read_b128 v[120:123], v10 offset:0
    ds_read_b64 v[128:129], v12 offset:0
    ds_read_b128 v[132:135], v13 offset:0
    ds_read_b128 v[136:139], v13 offset:640
    s_waitcnt lgkmcnt(0)
    s_branch F_retry
F_nspin6:
    s_mov_b32 s101, 30000
F_nspin6l:
    v_mov_b32 v252, 0
    global_load_dwordx2 v[252:253], v252, s[72:73] sc1
    s_waitcnt vmcnt(0)
    v_readfirstlane_b32 s32, v252
    v_readfirstlane_b32 s33, v253
    s_sub_u32 s101, s101, 1
    s_cmp_eq_u32 s101, 0
    s_cbranch_scc1 F_done
    s_cmp_eq_u32 s32, 0
    s_cbranch_scc1 F_nspin6l
    s_branch F_nz5
F_spin8:
    s_mov_b32 s101, 30000
F_spin8l:
    buffer_load_dwordx2 v[94:95], v11, s[24:27], 0 offen sc1
    s_waitcnt vmcnt(0)
    s_add_u32 s4, s32, 1
    v_xor_b32 v95, s33, v95
    v_subrev_u32 v94, s4, v94
    v_lshrrev_b32 v94, 3, v94
    v_or_b32 v95, v95, v94
    v_cmp_ne_u32 vcc, 0, v95
    s_sub_u32 s101, s101, 1
    s_cmp_eq_u32 s101, 0
    s_cbranch_scc1 F_done
    s_nop 1
    s_cbranch_vccnz F_spin8l
    s_branch F_ok7
F_nspin24:
    s_mov_b32 s101, 30000
F_nspin24l:
    v_mov_b32 v252, 0
    global_load_dwordx2 v[252:253], v252, s[72:73] sc1
    s_waitcnt vmcnt(0)
    v_readfirstlane_b32 s32, v252
    v_readfirstlane_b32 s33, v253
    s_sub_u32 s101, s101, 1
    s_cmp_eq_u32 s101, 0
    s_cbranch_scc1 F_done
    s_cmp_eq_u32 s32, 0
    s_cbranch_scc1 F_nspin24l
    s_branch F_nz23
F_spin26:
    s_mov_b32 s101, 30000
F_spin26l:
    buffer_load_dwordx2 v[94:95], v11, s[24:27], 0 offen sc1
    s_waitcnt vmcnt(0)
    s_add_u32 s4, s32, 1
    v_xor_b32 v95, s33, v95
    v_subrev_u32 v94, s4, v94
    v_lshrrev_b32 v94, 3, v94
    v_or_b32 v95, v95, v94
    v_cmp_ne_u32 vcc, 0, v95
    s_sub_u32 s101, s101, 1
    s_cmp_eq_u32 s101, 0
    s_cbranch_scc1 F_done
    s_nop 1
    s_cbranch_vccnz F_spin26l
    s_branch F_ok25
F_spin38:
    s_mov_b32 s101, 30000
F_spin38l:
    buffer_load_dwordx2 v[54:55], v11, s[24:27], 0 offen sc1
    s_waitcnt vmcnt(0)
    s_add_u32 s4, s32, 3
    v_xor_b32 v55, s33, v55
    v_subrev_u32 v54, s4, v54
    v_lshrrev_b32 v54, 3, v54
    v_or_b32 v55, v55, v54
    v_cmp_ne_u32 vcc, 0, v55
    s_sub_u32 s101, s101, 1
    s_cmp_eq_u32 s101, 0
    s_cbranch_scc1 F_done
    s_nop 1
    s_cbranch_vccnz F_spin38l
    s_branch F_ok37
F_spin44:
    s_mov_b32 s101, 30000
F_spin44l:
    buffer_load_dwordx2 v[240:241], v11, s[24:27], 0 offen sc1
    s_waitcnt vmcnt(0)
    s_add_u32 s4, s32, 4
    v_xor_b32 v241, s33, v241
    v_subrev_u32 v240, s4, v240
    v_lshrrev_b32 v240, 3, v240
    v_or_b32 v241, v241, v240
    v_cmp_ne_u32 vcc, 0, v241
    s_sub_u32 s101, s101, 1
    s_cmp_eq_u32 s101, 0
    s_cbranch_scc1 F_done
    s_nop 1
    s_cbranch_vccnz F_spin44l
    s_branch F_ok43
F_ps:
    s_setpc_b64 s[6:7]
F_s3:
    s_mov_b32 s101, 30000
    s_mov_b64 exec, 0xfffff
F_s3l:
    buffer_load_dword v171, v170, s[24:27], s53 offen sc1
    s_sub_u32 s101, s101, 1
    s_cmp_eq_u32 s101, 0
    s_cbranch_scc1 F_done
    s_waitcnt vmcnt(0)
    v_cmp_eq_u32 vcc, -1, v171
    s_nop 4
    s_cbranch_vccnz F_s3l
    s_mov_b64 exec, -1
    buffer_load_dwordx4 v[180:183], v1, s[24:27], s53 offen offset:0 sc1
    buffer_load_dwordx4 v[184:187], v1, s[24:27], s53 offen offset:1024 sc1
    buffer_load_dwordx4 v[188:191], v1, s[24:27], s53 offen offset:2048 sc1
    buffer_load_dwordx4 v[192:195], v1, s[24:27], s53 offen offset:3072 sc1
    buffer_load_dwordx4 v[196:199], v1, s[24:27], s54 offen sc1
    s_waitcnt vmcnt(0)
    v_max_u32 v164, v180, v181
    v_max3_u32 v164, v164, v182, v183
    v_max3_u32 v164, v164, v184, v185
    v_max3_u32 v164, v164, v186, v187
    v_max3_u32 v164, v164, v188, v189
    v_max3_u32 v164, v164, v190, v191
    v_max3_u32 v164, v164, v192, v193
    v_max3_u32 v164, v164, v194, v195
    v_max3_u32 v164, v164, v196, v197
    v_max3_u32 v164, v164, v198, v199
    v_cmp_eq_u32 vcc, -1, v164
    s_nop 4
    s_cbranch_vccz F_s3k
    s_mov_b64 exec, 0xfffff
    s_branch F_s3l
F_done:
    s_endpgm
.section .rodata,"a"
.p2align 6
.amdhsa_kernel parallel_sum__mha_block__glu_gated_glu__prompt_kernel
  .amdhsa_next_free_vgpr 256
  .amdhsa_next_free_sgpr 102
  .amdhsa_accum_offset 256
  .amdhsa_group_segment_fixed_size 0
  .amdhsa_kernarg_size 80
  .amdhsa_user_sgpr_count 2
  .amdhsa_user_sgpr_kernarg_segment_ptr 1
  .amdhsa_system_sgpr_workgroup_id_x 1
.end_amdhsa_kernel
```
